```python
import torch

def _softmax(x, axis=-1):
    return torch.softmax(x, dim=axis)
def _gelu(x):
    return torch.nn.functional.gelu(x, approximate="tanh")
def _silu(x):
    return torch.nn.functional.silu(x)
def _sigmoid(x):
    return torch.sigmoid(x)
def _layernorm(x, axis=-1, eps=1e-5):
    m = x.mean(dim=axis, keepdim=True)
    v = x.var(dim=axis, keepdim=True, unbiased=False)
    return (x - m) / torch.sqrt(v + eps)
def _scatter_add(tgt, idx, src, axis=0):
    return tgt.clone().index_add_(axis, idx, src)
def _segment_sum(src, seg, n):
    out = torch.zeros((n,) + src.shape[1:], dtype=src.dtype)
    return out.index_add_(0, seg, src)
def _pad(x, pw):
    flat = tuple(v for pair in reversed(pw) for v in pair)
    return torch.nn.functional.pad(x, flat)

kernel_name = 'sequential_preLN__ssm_conv_h3__moe_arch_mod__prompt'

def setup_inputs():

    _w = (lambda a: (lambda t: t.to(torch.bfloat16) if t.is_floating_point() else t)(torch.as_tensor(a)))
    def _A_setup():
        B, S, D = 1, 2048, 1024
        ks = 4
        return {
            "q": _w((lambda *s: torch.randn(*s, dtype=torch.bfloat16) * 0.05)(B, S, D)),
            "k": _w((lambda *s: torch.randn(*s, dtype=torch.bfloat16) * 0.4)(B, S, D)),
            "v": _w((lambda *s: torch.randn(*s, dtype=torch.bfloat16) * 0.4)(B, S, D)),
            "shift_k": _w((lambda *s: torch.randn(*s, dtype=torch.bfloat16) * 0.4)(D, ks) * 0.5),
            "ssm_k": _w((lambda *s: torch.randn(*s, dtype=torch.bfloat16) * 0.4)(D, S) * (1.0 / S ** 0.5)),
            "ssm_D": _w((lambda *s: torch.randn(*s, dtype=torch.bfloat16) * 0.4)(D)),
        }
    _A_in = _A_setup()

    def _B_setup():
        B, S, D, F, C = 1, 2048, 1024, 3584, 1
        return {
            "x": _w((lambda *s: torch.randn(*s, dtype=torch.bfloat16) * 0.05)(B, S, D)),
            "w_r": _w((lambda *s: torch.randn(*s, dtype=torch.bfloat16) * 0.05)(D)),
            "w_gate": _w((lambda *s: torch.randn(*s, dtype=torch.bfloat16) * 0.05)(D, F)),
            "w_up": _w((lambda *s: torch.randn(*s, dtype=torch.bfloat16) * 0.05)(D, F)),
            "w_down": _w((lambda *s: torch.randn(*s, dtype=torch.bfloat16) * 0.05)(F, D)),
        }
    _B_in = _B_setup()

    return {
        "A_q": _A_in["q"],
        "A_k": _A_in["k"],
        "A_v": _A_in["v"],
        "A_shift_k": _A_in["shift_k"],
        "A_ssm_k": _A_in["ssm_k"],
        "A_ssm_D": _A_in["ssm_D"],
        "B_x": _B_in["x"],
        "B_w_r": _B_in["w_r"],
        "B_w_gate": _B_in["w_gate"],
        "B_w_up": _B_in["w_up"],
        "B_w_down": _B_in["w_down"],
    }

def reference(A_q, A_k, A_v, A_shift_k, A_ssm_k, A_ssm_D, B_x, B_w_r, B_w_gate, B_w_up, B_w_down):
    def _A_ref(q, k, v, shift_k, ssm_k, ssm_D):
        B, S, D = q.shape
        ks = shift_k.shape[-1]
        k_pad = _pad(k, ((0, 0), (ks - 1, 0), (0, 0)))
        k_shift = torch.zeros_like(k)
        for t in range(ks):
            k_shift = k_shift + k_pad[:, t:t + S, :] * shift_k[:, ks - 1 - t][None, None, :]
        kv = k_shift * v
        L = 2 * S
        kv_pad = _pad(kv, ((0, 0), (0, S), (0, 0)))
        kf_pad = _pad(ssm_k, ((0, 0), (0, S)))
        kv_f = (lambda x, axes=(-2,-1): torch.fft.rfft2(x.float(), dim=axes))(kv_pad[:, None, :, :], axes=(1, 2))
        kf_f = (lambda x, axes=(-2,-1): torch.fft.rfft2(x.float(), dim=axes))(kf_pad[:, None, :], axes=(1, 2))
        kf_f = (lambda x, *d: x.permute(*d))(kf_f, 1, 2, 0)
        y_f = kv_f * kf_f[None, :, :, :]
        y = (lambda x, s, axes=(-2,-1): torch.fft.irfft2(x, s=s, dim=axes).to(torch.bfloat16))(y_f, (1, L), axes=(1, 2))[:, 0, :S, :]
        y = y + kv * ssm_D[None, None, :]
        return q * y

    def _B_ref(x, w_r, w_gate, w_up, w_down):
        B, S, D = x.shape
        C = 1
        r = x @ w_r
        idx = torch.argsort(-r, axis=-1)[:, :C]
        idx_e = (lambda x, n, axis: torch.repeat_interleave(x, n, dim=axis))(idx.reshape(B, C, 1), D, axis=2)
        x_sel = (lambda x, i, axis: torch.take_along_dim(x, i, dim=axis))(x, idx_e, axis=1)
        g = _silu(x_sel @ w_gate)
        u = x_sel @ w_up
        y = (g * u) @ w_down
        r_sel = _sigmoid((lambda x, i, axis: torch.take_along_dim(x, i, dim=axis))(r, idx, axis=1))
        y = y * r_sel.reshape(B, C, 1)
        b_off = (torch.arange(B) * S).reshape(B, 1)
        flat_idx = (idx + b_off).reshape(B * C)
        zero = (x * 0.0).reshape(B * S, D)
        upd = _scatter_add(zero, flat_idx, y.reshape(B * C, D), axis=0)
        return x + upd.reshape(B, S, D)

    x = A_q
    h = x + _A_ref(_layernorm(x, axis=-1), A_k, A_v, A_shift_k, A_ssm_k, A_ssm_D)
    h2 = h + _B_ref(_layernorm(h, axis=-1), B_w_r, B_w_gate, B_w_up, B_w_down)
    return h2
```

```asm
; @launch grid=(256,1,1) block=(512,1,1) lds=142160
.amdgcn_target "amdgcn-amd-amdhsa--gfx950"
.text
.globl sequential_preLN__ssm_conv_h3__moe_arch_mod__prompt_kernel
.p2align 8
.type sequential_preLN__ssm_conv_h3__moe_arch_mod__prompt_kernel,@function
sequential_preLN__ssm_conv_h3__moe_arch_mod__prompt_kernel:
    s_cmp_ge_u32 s2, 256
    s_cbranch_scc1 main_done
    s_load_dwordx2 s[32:33], s[0:1], 104
    s_load_dwordx2 s[16:17], s[0:1], 8
    s_load_dwordx2 s[20:21], s[0:1], 16
    s_load_dwordx2 s[24:25], s[0:1], 24
    s_load_dwordx2 s[28:29], s[0:1], 32
    s_load_dwordx2 s[10:11], s[0:1], 40
    s_load_dwordx2 s[36:37], s[0:1], 0
    s_load_dwordx2 s[40:41], s[0:1], 56
    s_load_dwordx2 s[44:45], s[0:1], 88
    s_load_dwordx2 s[48:49], s[0:1], 64
    s_load_dwordx2 s[52:53], s[0:1], 72
    s_load_dwordx2 s[56:57], s[0:1], 80
    s_getpc_b64 s[4:5]
pc0:
    s_mov_b32 s6, main_done-pc0
    s_mov_b32 s7, 0x00020000
    s_lshr_b32 s3, s2, 3
    s_mul_i32 s3, s3, 896
    v_lshlrev_b32 v3, 7, v0
    v_cmp_gt_u32 vcc, 7, v0
    s_nop 0
    s_and_saveexec_b64 s[60:61], vcc
    s_nop 1
    s_cbranch_execz no_codepf
    buffer_load_dword v250, v3, s[4:7], s3 offen
no_codepf:
    s_mov_b64 exec, -1
    s_lshr_b32 s5, s2, 4
    s_add_u32 s4, s2, 0
    s_and_b32 s4, s4, 7
    s_lshl_b32 s4, s4, 1
    s_bfe_u32 s6, s2, 0x10003
    s_or_b32 s4, s4, s6
    s_lshl_b32 s2, s4, 4
    s_or_b32 s2, s2, s5
    v_lshrrev_b32 v3, 6, v0
    v_and_b32 v1, 63, v0
    v_readfirstlane_b32 s12, v3
    v_lshlrev_b32 v2, 4, v1
    v_mov_b32 v254, 136976
    v_mov_b32 v255, 1
    v_mov_b32 v144, 0
    v_mov_b32 v145, 0
    v_mov_b32 v146, 0
    v_mov_b32 v147, 0
    v_mov_b32 v148, 0
    v_mov_b32 v149, 0
    v_mov_b32 v240, -1
    v_mov_b32 v241, -1
    v_mov_b32 v242, -1
    v_mov_b32 v243, -1
    s_cmp_eq_u32 s12, 0
    s_cbranch_scc0 no_cnt_init
    s_mov_b64 exec, 1
    ds_write_b128 v254, v[144:147]
    ds_write_b128 v254, v[144:147] offset:16
    ds_write_b128 v254, v[144:147] offset:32
    s_mov_b64 exec, -1
    s_nop 0
no_cnt_init:
    s_mov_b32 s34, 7340032
    s_mov_b32 s35, 0x00020000
    s_mov_b32 s18, 4194304
    s_mov_b32 s19, 0x00020000
    s_mov_b32 s22, 4194304
    s_mov_b32 s23, 0x00020000
    s_mov_b32 s26, 8192
    s_mov_b32 s27, 0x00020000
    s_mov_b32 s30, 4096
    s_mov_b32 s31, 0x00020000
    s_mov_b32 s38, 4194304
    s_mov_b32 s39, 0x00020000
    s_mov_b32 s42, 2048
    s_mov_b32 s43, 0x00020000
    s_mov_b32 s46, 4194304
    s_mov_b32 s47, 0x00020000
    s_mov_b32 s50, 7340032
    s_mov_b32 s51, 0x00020000
    s_mov_b32 s54, 7340032
    s_mov_b32 s55, 0x00020000
    s_mov_b32 s58, 7340032
    s_mov_b32 s59, 0x00020000
    s_and_b32 s13, s12, 3
    s_and_b32 s14, s12, 1
    s_xor_b32 s4, s4, s14
    s_lshr_b32 s14, s12, 2
    s_xor_b32 s7, s4, 0
    s_xor_b32 s15, s2, 0
    s_lshl_b32 s15, s15, 2
    s_add_u32 s15, s15, s13
    s_lshr_b32 s3, s2, 1
    v_and_b32 v4, 15, v1
    v_lshrrev_b32 v5, 4, v1
    v_and_b32 v10, 31, v1
    v_lshrrev_b32 v11, 5, v1
    v_lshrrev_b32 v6, 3, v1
    v_lshlrev_b32 v8, 11, v6
    v_lshlrev_b32 v6, 13, v6
    v_and_b32 v7, 7, v1
    v_lshl_add_u32 v6, v7, 4, v6
    v_lshl_add_u32 v8, v7, 4, v8
    s_lshl_b32 s62, s4, 17
    s_lshl_b32 s63, s13, 11
    s_add_u32 s62, s62, s63
    s_lshl_b32 s63, s14, 21
    s_add_u32 s62, s62, s63
    s_add_u32 s62, s62, 2097152
    s_lshl_b32 s63, s5, 7
    s_add_u32 s62, s62, s63
    s_add_u32 s63, s62, 0x10000
    s_lshl_b32 s64, s12, 19
    s_lshl_b32 s65, s5, 15
    s_add_u32 s64, s64, s65
    s_lshl_b32 s65, s7, 7
    s_add_u32 s64, s64, s65
    s_add_u32 s65, s64, 16384
    s_sub_u32 s77, s64, 6144
    s_cselect_b32 s77, 0x40000000, s77
    s_lshl_b32 s79, s7, 9
    v_lshlrev_b32 v9, 4, v10
    s_lshl_b32 s67, s15, 12
    s_lshl_b32 s70, s15, 1
    s_and_b32 s70, s70, 0xfffffffc
    s_xor_b32 s68, s3, 0
    s_lshl_b32 s68, s68, 4
    s_lshl_b32 s69, s13, 2
    s_add_u32 s68, s68, s69
    s_lshl_b32 s69, s68, 11
    s_mul_i32 s66, s12, 4608
    s_add_u32 s66, s66, 85248
    s_mov_b32 s6, 32768
    s_mov_b32 m0, s66
    s_waitcnt lgkmcnt(0)
    s_load_dword s8, s[32:33], s6
    s_load_dword s9, s[10:11], s70
    s_cmp_eq_u32 s14, 0
    s_cbranch_scc1 ld_kv
    s_add_u32 s28, s28, s67
    s_addc_u32 s29, s29, 0
    s_barrier
    buffer_load_dwordx4 v[96:99], v2, s[28:31], 0 offen offset:0 nt
    buffer_load_dwordx4 v[102:105], v2, s[28:31], 0 offen offset:1024 nt
    buffer_load_dwordx4 v[108:111], v2, s[28:31], 0 offen offset:2048 nt
    buffer_load_dwordx4 v[114:117], v2, s[28:31], 0 offen offset:3072 nt
ld_kv:
    buffer_load_dwordx4 v[36:39], v9, s[24:27], s79 offen
    s_mov_b64 exec, 0xffffff
    buffer_load_dwordx4 v8, s[16:19], s77 offen nt lds
    s_mov_b64 exec, -1
    s_add_u32 m0, s66, 384
    s_nop 0
    buffer_load_dwordx4 v8, s[16:19], s64 offen nt lds
    s_add_u32 m0, s66, 1408
    s_nop 0
    buffer_load_dwordx4 v8, s[16:19], s65 offen nt lds
    s_add_u32 m0, s66, 2432
    s_nop 0
    buffer_load_dwordx4 v8, s[20:23], s64 offen nt lds
    s_add_u32 m0, s66, 3456
    s_nop 0
    buffer_load_dwordx4 v8, s[20:23], s65 offen nt lds
    s_cmp_eq_u32 s14, 0
    s_cbranch_scc0 ld_done
    s_barrier
ld_done:
    s_mul_i32 s67, s13, 21312
    s_mov_b32 s74, 0x05040100
    s_mov_b32 s75, 0x07060302
    v_lshlrev_b32 v92, 10, v11
    v_lshl_add_u32 v92, v10, 2, v92
    v_add_u32 v92, s66, v92
    v_add_u32 v93, 1024, v92
    v_add_u32 v94, 2432, v92
    v_lshrrev_b32 v8, 1, v10
    v_mul_u32_u24 v8, 144, v8
    v_and_b32 v9, 1, v10
    v_lshl_add_u32 v8, v9, 6, v8
    v_sub_u32 v9, 1, v11
    v_lshl_add_u32 v8, v9, 4, v8
    v_add_u32 v8, s66, v8
    v_lshrrev_b32 v9, 3, v1
    v_mul_u32_u24 v9, 144, v9
    v_lshl_add_u32 v9, v7, 4, v9
    v_add_u32 v9, s66, v9
    v_add_u32 v160, s67, v2
    v_and_b32 v161, 3, v1
    v_mul_u32_u24 v161, 4160, v161
    v_bfe_u32 v162, v1, 2, 2
    v_lshl_add_u32 v161, v162, 3, v161
    v_lshl_add_u32 v161, v5, 4, v161
    v_add_u32 v161, s67, v161
    s_add_u32 s60, s67, 17120
    v_lshlrev_b32 v163, 5, v4
    v_sub_u32 v162, s60, v163
    v_lshl_add_u32 v162, v5, 4, v162
    v_lshl_add_u32 v163, v5, 3, v163
    s_lshl_b32 s60, s13, 12
    s_add_u32 s60, s60, 85248
    v_add_u32 v163, s60, v163
    v_bfe_u32 v165, v1, 1, 2
    v_mul_u32_u24 v165, 21312, v165
    v_and_b32 v166, 1, v1
    v_lshl_add_u32 v165, v166, 4, v165
    v_lshrrev_b32 v166, 3, v1
    v_lshlrev_b32 v166, 5, v166
    v_sub_u32 v165, v165, v166
    s_lshl_b32 s60, s12, 9
    s_sub_u32 s60, 20448, s60
    v_add_u32 v165, s60, v165
    s_lshl_b32 s78, s2, 13
    s_lshl_b32 s60, s13, 11
    s_add_u32 s78, s78, s60
    s_lshl_b32 s60, s14, 21
    s_add_u32 s78, s78, s60
    s_add_u32 s78, s78, 2097152
    v_lshl_add_u32 v166, v5, 3, v4
    v_sub_u32 v166, 15, v166
    v_and_b32 v167, 1, v166
    v_lshlrev_b32 v167, 4, v167
    v_ashrrev_i32 v166, 1, v166
    v_mul_u32_u24 v150, 4160, v1
    v_add_u32 v150, s67, v150
    v_lshlrev_b32 v245, 7, v4
    v_bfe_u32 v248, v1, 3, 2
    v_lshlrev_b32 v248, 13, v248
    v_lshl_add_u32 v248, v7, 7, v248
    v_lshlrev_b32 v251, 4, v0
    v_bfe_u32 v238, v0, 3, 5
    v_lshlrev_b32 v238, 15, v238
    v_lshl_add_u32 v238, v7, 4, v238
    v_lshrrev_b32 v228, 3, v0
    v_lshlrev_b32 v228, 3, v228
    v_mul_u32_u24 v229, 4128, v7
    v_add_u32 v229, v229, v228
    v_add_u32 v229, 101632, v229
    v_add_u32 v230, 134656, v228
    v_lshlrev_b32 v231, 5, v7
    v_add_u32 v231, 136704, v231
    v_bfe_u32 v232, v1, 3, 1
    v_lshl_add_u32 v232, v7, 1, v232
    v_mul_u32_u24 v233, 272, v232
    v_lshl_add_u32 v233, v5, 6, v233
    v_lshl_add_u32 v234, v7, 1, v11
    v_mul_u32_u24 v234, 272, v234
    v_and_b32 v3, 1, v5
    v_lshl_add_u32 v234, v3, 4, v234
    s_lshl_b32 s60, s12, 5
    v_add_u32 v234, s60, v234
    s_xor_b32 s60, s3, 0
    s_lshl_b32 s60, s60, 4
    s_sub_u32 s60, 2047, s60
    v_sub_u32 v232, s60, v232
    s_mul_i32 s60, s13, 8256
    s_add_u32 s60, s60, 101632
    v_add_u32 v235, s60, v2
    v_lshrrev_b32 v236, 3, v1
    v_lshlrev_b32 v236, v236, 1
    v_and_b32 v253, 255, v0
    v_lshlrev_b32 v253, 3, v253
    v_lshlrev_b32 v237, 1, v253
    v_lshlrev_b32 v247, 14, v4
    v_lshl_add_u32 v247, v11, 7, v247
    v_and_b32 v3, 1, v5
    v_lshl_add_u32 v247, v3, 4, v247
    v_mul_u32_u24 v252, 114688, v5
    v_lshl_add_u32 v252, v4, 4, v252
    s_mov_b64 exec, 0xf
    ds_write_b128 v150, v[144:147]
    s_mov_b64 exec, 0x3fffffff
    ds_write_b128 v160, v[144:147] offset:20736
    s_mov_b64 exec, -1
    s_waitcnt lgkmcnt(0)
    s_add_u32 s8, s8, 0x9e3779b9
    s_or_b32 s8, s8, 1
    s_and_b32 s61, s15, 1
    s_lshl_b32 s61, s61, 4
    s_lshr_b32 s9, s9, s61
    s_and_b32 s9, s9, 0xffff
    v_lshlrev_b32 v167, v167, s9
    v_cmp_eq_u32 vcc, 0, v166
    s_nop 1
    v_cndmask_b32 v168, 0, v167, vcc
    v_cmp_eq_u32 vcc, 1, v166
    s_nop 1
    v_cndmask_b32 v169, 0, v167, vcc
    v_cmp_eq_u32 vcc, 2, v166
    s_nop 1
    v_cndmask_b32 v170, 0, v167, vcc
    v_cmp_eq_u32 vcc, 3, v166
    s_nop 1
    v_cndmask_b32 v171, 0, v167, vcc
    s_lshl_b32 s64, s4, 11
    s_add_u32 s64, s64, 131072
    s_lshl_b32 s65, s2, 7
    s_lshr_b32 s15, s15, 2
    s_lshl_b32 s15, s15, 7
    s_add_u32 s7, s15, 196608
    s_lshl_b32 s60, s13, 2
    s_add_u32 s7, s7, s60
    s_bfe_u32 s60, s3, 0x20003
    s_lshl_b32 s60, s60, 2
    v_add_u32 v248, s60, v248
    s_add_u32 s65, s65, 131072
    v_mov_b32 v13, s8
    v_mov_b32 v14, 0
    s_add_u32 s10, s65, -65536
    s_cmp_eq_u32 s12, 0
    s_cselect_b32 s60, s10, 0x40000000
    s_mov_b64 exec, 0xff
    buffer_store_dwordx4 v[144:147], v2, s[32:35], s60 offen
    s_mov_b64 exec, -1
    s_lshl_b32 s60, s12, 2
    s_add_u32 s64, s64, s60
    s_add_u32 s65, s65, s60
    s_add_u32 s10, s10, s60
    s_add_u32 s11, s64, -65536
    s_cmp_eq_u32 s14, 0
    s_cbranch_scc1 p0
    s_waitcnt vmcnt(10)
    v_readlane_b32 s76, v96, 0
    v_readlane_b32 s77, v97, 0
    s_lshl_b32 s70, s76, 16
    s_lshr_b32 s61, s76, 16
    s_lshl_b32 s71, s77, 16
    s_or_b32 s61, s61, s71
    v_writelane_b32 v149, s70, 0
    v_writelane_b32 v149, s76, 1
    v_writelane_b32 v149, s61, 2
    v_writelane_b32 v149, s77, 3
    v_writelane_b32 v148, s70, 2
    v_writelane_b32 v148, s76, 3
    s_mov_b64 exec, 0xf
    ds_write_b128 v150, v[146:149] offset:16
    s_mov_b64 exec, -1
    s_nop 0
    v_mov_b32_dpp v100, v96 wave_shl:1 row_mask:0xf bank_mask:0xf bound_ctrl:0
    v_mov_b32_dpp v101, v97 wave_shl:1 row_mask:0xf bank_mask:0xf bound_ctrl:0
    s_waitcnt vmcnt(9)
    v_readlane_b32 s70, v102, 0
    v_readlane_b32 s71, v103, 0
    s_nop 0
    v_writelane_b32 v100, s70, 63
    v_writelane_b32 v101, s71, 63
    ds_write_b128 v160, v[98:101] offset:12512
    v_alignbit_b32 v176, v97, v96, 16
    v_alignbit_b32 v177, v98, v97, 16
    v_alignbit_b32 v178, v99, v98, 16
    v_alignbit_b32 v179, v100, v99, 16
    ds_write_b128 v160, v[176:179] offset:32
    v_alignbit_b32 v180, v98, v97, 16
    v_alignbit_b32 v181, v99, v98, 16
    v_alignbit_b32 v182, v100, v99, 16
    v_alignbit_b32 v183, v101, v100, 16
    ds_write_b128 v160, v[180:183] offset:8352
    v_mov_b32 v184, v97
    v_mov_b32 v185, v98
    v_mov_b32 v186, v99
    v_mov_b32 v187, v100
    ds_write_b128 v160, v[184:187] offset:4192
    v_mov_b32_dpp v106, v102 wave_shl:1 row_mask:0xf bank_mask:0xf bound_ctrl:0
    v_mov_b32_dpp v107, v103 wave_shl:1 row_mask:0xf bank_mask:0xf bound_ctrl:0
    s_waitcnt vmcnt(8)
    v_readlane_b32 s70, v108, 0
    v_readlane_b32 s71, v109, 0
    s_nop 0
    v_writelane_b32 v106, s70, 63
    v_writelane_b32 v107, s71, 63
    ds_write_b128 v160, v[104:107] offset:13536
    v_alignbit_b32 v188, v103, v102, 16
    v_alignbit_b32 v189, v104, v103, 16
    v_alignbit_b32 v190, v105, v104, 16
    v_alignbit_b32 v191, v106, v105, 16
    ds_write_b128 v160, v[188:191] offset:1056
    v_alignbit_b32 v192, v104, v103, 16
    v_alignbit_b32 v193, v105, v104, 16
    v_alignbit_b32 v194, v106, v105, 16
    v_alignbit_b32 v195, v107, v106, 16
    ds_write_b128 v160, v[192:195] offset:9376
    v_mov_b32 v196, v103
    v_mov_b32 v197, v104
    v_mov_b32 v198, v105
    v_mov_b32 v199, v106
    ds_write_b128 v160, v[196:199] offset:5216
    v_mov_b32_dpp v112, v108 wave_shl:1 row_mask:0xf bank_mask:0xf bound_ctrl:0
    v_mov_b32_dpp v113, v109 wave_shl:1 row_mask:0xf bank_mask:0xf bound_ctrl:0
    s_waitcnt vmcnt(7)
    v_readlane_b32 s70, v114, 0
    v_readlane_b32 s71, v115, 0
    s_nop 0
    v_writelane_b32 v112, s70, 63
    v_writelane_b32 v113, s71, 63
    ds_write_b128 v160, v[110:113] offset:14560
    v_alignbit_b32 v200, v109, v108, 16
    v_alignbit_b32 v201, v110, v109, 16
    v_alignbit_b32 v202, v111, v110, 16
    v_alignbit_b32 v203, v112, v111, 16
    ds_write_b128 v160, v[200:203] offset:2080
    v_alignbit_b32 v204, v110, v109, 16
    v_alignbit_b32 v205, v111, v110, 16
    v_alignbit_b32 v206, v112, v111, 16
    v_alignbit_b32 v207, v113, v112, 16
    ds_write_b128 v160, v[204:207] offset:10400
    v_mov_b32 v208, v109
    v_mov_b32 v209, v110
    v_mov_b32 v210, v111
    v_mov_b32 v211, v112
    ds_write_b128 v160, v[208:211] offset:6240
    v_mov_b32_dpp v118, v114 wave_shl:1 row_mask:0xf bank_mask:0xf bound_ctrl:0
    v_mov_b32_dpp v119, v115 wave_shl:1 row_mask:0xf bank_mask:0xf bound_ctrl:0
    ds_write_b128 v160, v[116:119] offset:15584
    v_alignbit_b32 v212, v115, v114, 16
    v_alignbit_b32 v213, v116, v115, 16
    v_alignbit_b32 v214, v117, v116, 16
    v_alignbit_b32 v215, v118, v117, 16
    ds_write_b128 v160, v[212:215] offset:3104
    v_alignbit_b32 v216, v116, v115, 16
    v_alignbit_b32 v217, v117, v116, 16
    v_alignbit_b32 v218, v118, v117, 16
    v_alignbit_b32 v219, v119, v118, 16
    ds_write_b128 v160, v[216:219] offset:11424
    v_mov_b32 v220, v115
    v_mov_b32 v221, v116
    v_mov_b32 v222, v117
    v_mov_b32 v223, v118
    ds_write_b128 v160, v[220:223] offset:7264
    s_mov_b64 exec, 1
    ds_add_u32 v254, v255 offset:20
    s_mov_b64 exec, -1
    v_add_u32 v239, 134656, v2
    v_and_b32 v244, 1, v5
    v_lshl_add_u32 v244, v244, 1, v11
    v_lshlrev_b32 v244, 4, v244
    s_lshl_b32 s60, s13, 6
    s_add_u32 s60, s60, 136704
    v_add_u32 v244, s60, v244
    s_waitcnt lgkmcnt(0)
    v_mov_b32 v140, -1
    v_mov_b32 v144, -1
    v_mov_b32 v148, -1
    v_mov_b32 v152, -1
    v_lshlrev_b32 v201, 5, v5
    v_add_u32 v201, 137040, v201
    s_nop 1
p0:
    s_waitcnt vmcnt(6)
    v_lshlrev_b32 v40, 16, v36
    v_and_b32 v42, 0xffff0000, v36
    v_lshlrev_b32 v44, 16, v37
    v_and_b32 v46, 0xffff0000, v37
    v_lshlrev_b32 v41, 16, v38
    v_and_b32 v43, 0xffff0000, v38
    v_lshlrev_b32 v45, 16, v39
    v_and_b32 v47, 0xffff0000, v39
    s_waitcnt vmcnt(3)
    ds_read2_b32 v[16:17], v92 offset0:0 offset1:32
    ds_read2_b32 v[18:19], v92 offset0:64 offset1:96
    ds_read2_b32 v[20:21], v92 offset0:128 offset1:160
    ds_read2_b32 v[22:23], v92 offset0:192 offset1:224
    ds_read2_b32 v[24:25], v93 offset0:0 offset1:32
    ds_read_b32 v26, v93 offset:256
    s_waitcnt vmcnt(1)
    ds_read2_b32 v[28:29], v94 offset0:0 offset1:32
    ds_read2_b32 v[30:31], v94 offset0:64 offset1:96
    ds_read2_b32 v[32:33], v94 offset0:128 offset1:160
    ds_read2_b32 v[34:35], v94 offset0:192 offset1:224
    s_waitcnt lgkmcnt(9)
    v_lshlrev_b32 v48, 16, v16
    v_and_b32 v49, 0xffff0000, v16
    v_lshlrev_b32 v50, 16, v17
    v_and_b32 v51, 0xffff0000, v17
    s_waitcnt lgkmcnt(8)
    v_lshlrev_b32 v52, 16, v18
    v_and_b32 v53, 0xffff0000, v18
    v_lshlrev_b32 v54, 16, v19
    v_and_b32 v55, 0xffff0000, v19
    s_waitcnt lgkmcnt(7)
    v_lshlrev_b32 v56, 16, v20
    v_and_b32 v57, 0xffff0000, v20
    v_lshlrev_b32 v58, 16, v21
    v_and_b32 v59, 0xffff0000, v21
    s_waitcnt lgkmcnt(6)
    v_lshlrev_b32 v60, 16, v22
    v_and_b32 v61, 0xffff0000, v22
    v_lshlrev_b32 v62, 16, v23
    v_and_b32 v63, 0xffff0000, v23
    s_waitcnt lgkmcnt(5)
    v_lshlrev_b32 v64, 16, v24
    v_and_b32 v65, 0xffff0000, v24
    v_lshlrev_b32 v66, 16, v25
    v_and_b32 v67, 0xffff0000, v25
    s_waitcnt lgkmcnt(4)
    v_lshlrev_b32 v68, 16, v26
    v_and_b32 v69, 0xffff0000, v26
    v_pk_mul_f32 v[70:71], v[48:49], v[46:47]
    v_pk_mul_f32 v[72:73], v[50:51], v[46:47]
    v_pk_mul_f32 v[74:75], v[52:53], v[46:47]
    v_pk_mul_f32 v[76:77], v[54:55], v[46:47]
    v_pk_mul_f32 v[78:79], v[56:57], v[46:47]
    v_pk_mul_f32 v[80:81], v[58:59], v[46:47]
    v_pk_mul_f32 v[82:83], v[60:61], v[46:47]
    v_pk_mul_f32 v[84:85], v[62:63], v[46:47]
    v_pk_fma_f32 v[70:71], v[50:51], v[44:45], v[70:71]
    v_pk_fma_f32 v[72:73], v[52:53], v[44:45], v[72:73]
    v_pk_fma_f32 v[74:75], v[54:55], v[44:45], v[74:75]
    v_pk_fma_f32 v[76:77], v[56:57], v[44:45], v[76:77]
    v_pk_fma_f32 v[78:79], v[58:59], v[44:45], v[78:79]
    v_pk_fma_f32 v[80:81], v[60:61], v[44:45], v[80:81]
    v_pk_fma_f32 v[82:83], v[62:63], v[44:45], v[82:83]
    v_pk_fma_f32 v[84:85], v[64:65], v[44:45], v[84:85]
    v_pk_fma_f32 v[70:71], v[52:53], v[42:43], v[70:71]
    v_pk_fma_f32 v[72:73], v[54:55], v[42:43], v[72:73]
    v_pk_fma_f32 v[74:75], v[56:57], v[42:43], v[74:75]
    v_pk_fma_f32 v[76:77], v[58:59], v[42:43], v[76:77]
    v_pk_fma_f32 v[78:79], v[60:61], v[42:43], v[78:79]
    v_pk_fma_f32 v[80:81], v[62:63], v[42:43], v[80:81]
    v_pk_fma_f32 v[82:83], v[64:65], v[42:43], v[82:83]
    v_pk_fma_f32 v[84:85], v[66:67], v[42:43], v[84:85]
    v_pk_fma_f32 v[70:71], v[54:55], v[40:41], v[70:71]
    v_pk_fma_f32 v[72:73], v[56:57], v[40:41], v[72:73]
    v_pk_fma_f32 v[74:75], v[58:59], v[40:41], v[74:75]
    v_pk_fma_f32 v[76:77], v[60:61], v[40:41], v[76:77]
    v_pk_fma_f32 v[78:79], v[62:63], v[40:41], v[78:79]
    v_pk_fma_f32 v[80:81], v[64:65], v[40:41], v[80:81]
    v_pk_fma_f32 v[82:83], v[66:67], v[40:41], v[82:83]
    v_pk_fma_f32 v[84:85], v[68:69], v[40:41], v[84:85]
    s_waitcnt lgkmcnt(0)
    v_lshlrev_b32 v48, 16, v28
    v_and_b32 v49, 0xffff0000, v28
    v_lshlrev_b32 v50, 16, v29
    v_and_b32 v51, 0xffff0000, v29
    v_lshlrev_b32 v52, 16, v30
    v_and_b32 v53, 0xffff0000, v30
    v_lshlrev_b32 v54, 16, v31
    v_and_b32 v55, 0xffff0000, v31
    v_lshlrev_b32 v56, 16, v32
    v_and_b32 v57, 0xffff0000, v32
    v_lshlrev_b32 v58, 16, v33
    v_and_b32 v59, 0xffff0000, v33
    v_lshlrev_b32 v60, 16, v34
    v_and_b32 v61, 0xffff0000, v34
    v_lshlrev_b32 v62, 16, v35
    v_and_b32 v63, 0xffff0000, v35
    v_pk_mul_f32 v[70:71], v[70:71], v[48:49]
    v_pk_mul_f32 v[72:73], v[72:73], v[50:51]
    v_pk_mul_f32 v[74:75], v[74:75], v[52:53]
    v_pk_mul_f32 v[76:77], v[76:77], v[54:55]
    v_pk_mul_f32 v[78:79], v[78:79], v[56:57]
    v_pk_mul_f32 v[80:81], v[80:81], v[58:59]
    v_pk_mul_f32 v[82:83], v[82:83], v[60:61]
    v_pk_mul_f32 v[84:85], v[84:85], v[62:63]
    v_cvt_pk_bf16_f32 v88, v84, v82
    v_cvt_pk_bf16_f32 v89, v80, v78
    v_cvt_pk_bf16_f32 v90, v76, v74
    v_cvt_pk_bf16_f32 v91, v72, v70
    ds_write_b128 v8, v[88:91] offset:0
    v_cvt_pk_bf16_f32 v92, v85, v83
    v_cvt_pk_bf16_f32 v93, v81, v79
    v_cvt_pk_bf16_f32 v94, v77, v75
    v_cvt_pk_bf16_f32 v95, v73, v71
    ds_write_b128 v8, v[92:95] offset:32
    s_waitcnt lgkmcnt(0)
    ds_read_b128 v[16:19], v9
    ds_read_b128 v[20:23], v9 offset:1152
    s_waitcnt lgkmcnt(1)
    buffer_store_dwordx4 v[16:19], v6, s[32:35], s62 offen sc1
    s_waitcnt lgkmcnt(0)
    buffer_store_dwordx4 v[20:23], v6, s[32:35], s63 offen sc1
    s_waitcnt vmcnt(0)
    s_mov_b64 exec, 1
    buffer_store_dword v13, v14, s[32:35], s10 offen
    buffer_store_dword v13, v14, s[32:35], s65 offen sc1
    s_mov_b64 exec, 0xffff
    s_mov_b32 s61, 0
fa2_again:
    buffer_load_dword v246, v245, s[32:35], s11 offen sc1
    s_add_u32 s61, s61, 1
    s_waitcnt vmcnt(0)
    v_cmp_ne_u32 vcc, s8, v246
    s_nop 3
    s_cbranch_vccz fa_ok
    s_mov_b64 exec, vcc
    s_cmp_lt_u32 s61, 8
    s_cbranch_scc1 fa2_again
    s_mov_b32 s61, 0
fa_again:
    buffer_load_dword v246, v245, s[32:35], s64 offen sc1
fa_chk:
    s_waitcnt vmcnt(0)
    v_cmp_ne_u32 vcc, s8, v246
    s_nop 3
    s_cbranch_vccz fa_ok
    s_add_u32 s61, s61, 1
    s_cmp_ge_u32 s61, 65536
    s_cbranch_scc1 fa_ok
    s_mov_b64 exec, vcc
    s_sleep 1
    s_branch fa_again
fa_ok:
    s_mov_b64 exec, -1
    buffer_load_dwordx4 v[120:123], v2, s[32:35], s78 offen offset:0 sc1
    buffer_load_dwordx4 v[124:127], v2, s[32:35], s78 offen offset:1024 sc1
    s_cmp_eq_u32 s14, 0
    s_cbranch_scc0 helper
    s_mov_b32 s61, 0
g4_spin:
    ds_read_b32 v153, v254 offset:20
    s_add_u32 s61, s61, 1
    s_waitcnt lgkmcnt(0)
    v_readfirstlane_b32 s60, v153
    s_nop 0
    s_cmp_ge_u32 s60, 4
    s_nop 1
    s_cbranch_scc1 g4_go
    s_cmp_ge_u32 s61, 4194304
    s_cbranch_scc1 g4_go
    s_sleep 1
    s_branch g4_spin
g4_go:
    ds_read_b64 v[48:49], v161 offset:0
    ds_read_b64 v[50:51], v161 offset:8
    ds_read_b64 v[52:53], v161 offset:512
    ds_read_b64 v[54:55], v161 offset:520
    ds_read_b64 v[56:57], v161 offset:1024
    ds_read_b64 v[58:59], v161 offset:1032
    ds_read_b64 v[60:61], v161 offset:1536
    ds_read_b64 v[62:63], v161 offset:1544
    ds_read_b64 v[64:65], v161 offset:2048
    ds_read_b64 v[66:67], v161 offset:2056
    ds_read_b64 v[68:69], v161 offset:2560
    ds_read_b64 v[70:71], v161 offset:2568
    ds_read_b64 v[72:73], v161 offset:3072
    ds_read_b64 v[74:75], v161 offset:3080
    ds_read_b64 v[76:77], v161 offset:3584
    ds_read_b64 v[78:79], v161 offset:3592
    s_waitcnt vmcnt(1)
    ds_write_b128 v165, v[120:123] offset:256
    s_waitcnt vmcnt(0)
    ds_write_b128 v165, v[124:127] offset:0
    s_mov_b64 exec, 1
    ds_add_u32 v254, v255 offset:12
    s_mov_b64 exec, -1
    s_mov_b32 s62, s15
    buffer_store_dwordx4 v[240:243], v238, s[44:47], s62 offen sc1
    s_add_u32 s62, s62, 0x100000
    buffer_store_dwordx4 v[240:243], v238, s[44:47], s62 offen sc1
    s_add_u32 s62, s62, 0x100000
    buffer_store_dwordx4 v[240:243], v238, s[44:47], s62 offen sc1
    s_add_u32 s62, s62, 0x100000
    buffer_store_dwordx4 v[240:243], v238, s[44:47], s62 offen sc1
    s_mov_b32 s61, 0
    s_nop 0
u4_spin:
    ds_read_b32 v153, v254 offset:12
    s_add_u32 s61, s61, 1
    s_waitcnt lgkmcnt(0)
    v_readfirstlane_b32 s60, v153
    s_nop 0
    s_cmp_ge_u32 s60, 4
    s_nop 1
    s_cbranch_scc1 u4_go
    s_cmp_ge_u32 s61, 4194304
    s_cbranch_scc1 u4_go
    s_sleep 1
    s_branch u4_spin
u4_go:
    ds_read_b128 v[80:83], v162 offset:3584
    ds_read_b128 v[84:87], v162 offset:3072
    ds_read_b128 v[88:91], v162 offset:2560
    ds_read_b128 v[92:95], v162 offset:2048
    s_waitcnt lgkmcnt(0)
    v_mfma_f32_16x16x32_bf16 v[16:19], v[168:171], v[80:83], 0
    ds_read_b128 v[112:115], v162 offset:3648
    v_mfma_f32_16x16x32_bf16 v[20:23], v[168:171], v[84:87], 0
    ds_read_b128 v[116:119], v162 offset:3136
    v_mfma_f32_16x16x32_bf16 v[24:27], v[168:171], v[88:91], 0
    ds_read_b128 v[120:123], v162 offset:2624
    v_mfma_f32_16x16x32_bf16 v[28:31], v[168:171], v[92:95], 0
    ds_read_b128 v[124:127], v162 offset:2112
    v_mfma_f32_16x16x32_bf16 v[16:19], v[48:51], v[80:83], v[16:19]
    ds_read_b64 v[196:197], v161 offset:64
    v_mfma_f32_16x16x32_bf16 v[20:23], v[48:51], v[84:87], v[20:23]
    ds_read_b64 v[198:199], v161 offset:72
    v_mfma_f32_16x16x32_bf16 v[24:27], v[48:51], v[88:91], v[24:27]
    ds_read_b64 v[200:201], v161 offset:576
    v_mfma_f32_16x16x32_bf16 v[28:31], v[48:51], v[92:95], v[28:31]
    ds_read_b64 v[202:203], v161 offset:584
    v_mfma_f32_16x16x32_bf16 v[20:23], v[52:55], v[80:83], v[20:23]
    ds_read_b64 v[204:205], v161 offset:1088
    v_mfma_f32_16x16x32_bf16 v[24:27], v[52:55], v[84:87], v[24:27]
    ds_read_b64 v[206:207], v161 offset:1096
    v_mfma_f32_16x16x32_bf16 v[28:31], v[52:55], v[88:91], v[28:31]
    ds_read_b64 v[208:209], v161 offset:1600
    v_mfma_f32_16x16x32_bf16 v[32:35], v[52:55], v[92:95], 0
    ds_read_b64 v[210:211], v161 offset:1608
    v_mfma_f32_16x16x32_bf16 v[24:27], v[56:59], v[80:83], v[24:27]
    ds_read_b64 v[212:213], v161 offset:2112
    v_mfma_f32_16x16x32_bf16 v[28:31], v[56:59], v[84:87], v[28:31]
    ds_read_b64 v[214:215], v161 offset:2120
    v_mfma_f32_16x16x32_bf16 v[32:35], v[56:59], v[88:91], v[32:35]
    ds_read_b64 v[216:217], v161 offset:2624
    v_mfma_f32_16x16x32_bf16 v[36:39], v[56:59], v[92:95], 0
    ds_read_b64 v[218:219], v161 offset:2632
    v_mfma_f32_16x16x32_bf16 v[28:31], v[60:63], v[80:83], v[28:31]
    ds_read_b64 v[220:221], v161 offset:3136
    v_mfma_f32_16x16x32_bf16 v[32:35], v[60:63], v[84:87], v[32:35]
    ds_read_b64 v[222:223], v161 offset:3144
    v_mfma_f32_16x16x32_bf16 v[36:39], v[60:63], v[88:91], v[36:39]
    ds_read_b64 v[224:225], v161 offset:3648
    v_mfma_f32_16x16x32_bf16 v[40:43], v[60:63], v[92:95], 0
    ds_read_b64 v[226:227], v161 offset:3656
    v_mfma_f32_16x16x32_bf16 v[32:35], v[64:67], v[80:83], v[32:35]
    v_lshlrev_b32 v180, 2, v0
    v_add_u32 v180, 85248, v180
    v_mfma_f32_16x16x32_bf16 v[36:39], v[64:67], v[84:87], v[36:39]
    v_add_u32 v181, 0x2000, v180
    s_mov_b32 s62, s15
    v_mfma_f32_16x16x32_bf16 v[40:43], v[64:67], v[88:91], v[40:43]
    s_add_u32 s63, s62, 0x100000
    s_add_u32 s64, s62, 0x200000
    v_mfma_f32_16x16x32_bf16 v[44:47], v[64:67], v[92:95], 0
    s_add_u32 s65, s62, 0x300000
    s_lshl_b32 s6, s12, 10
    v_mfma_f32_16x16x32_bf16 v[36:39], v[68:71], v[80:83], v[36:39]
    s_add_u32 s6, s6, 196608
    v_mfma_f32_16x16x32_bf16 v[44:47], v[68:71], v[88:91], v[44:47]
    v_mfma_f32_16x16x32_bf16 v[40:43], v[68:71], v[84:87], v[40:43]
    v_mfma_f32_16x16x32_bf16 v[44:47], v[72:75], v[84:87], v[44:47]
    s_bitcmp0_b32 s2, 0
    s_cselect_b32 s66, s69, 0x40000000
    s_cselect_b32 s70, 0, 0x40000000
    s_cselect_b32 s71, s6, 0x40000000
    v_mfma_f32_16x16x32_bf16 v[40:43], v[72:75], v[80:83], v[40:43]
    v_mfma_f32_16x16x32_bf16 v[44:47], v[76:79], v[80:83], v[44:47]
    s_waitcnt lgkmcnt(0)
    v_mfma_f32_16x16x32_bf16 v[16:19], v[196:199], v[112:115], v[16:19]
    ds_read_b128 v[80:83], v162 offset:3712
    v_mfma_f32_16x16x32_bf16 v[20:23], v[196:199], v[116:119], v[20:23]
    ds_read_b128 v[84:87], v162 offset:3200
    v_mfma_f32_16x16x32_bf16 v[24:27], v[196:199], v[120:123], v[24:27]
    ds_read_b128 v[88:91], v162 offset:2688
    v_mfma_f32_16x16x32_bf16 v[28:31], v[196:199], v[124:127], v[28:31]
    ds_read_b128 v[92:95], v162 offset:2176
    v_mfma_f32_16x16x32_bf16 v[20:23], v[200:203], v[112:115], v[20:23]
    ds_read_b64 v[48:49], v161 offset:128
    v_mfma_f32_16x16x32_bf16 v[24:27], v[200:203], v[116:119], v[24:27]
    ds_read_b64 v[50:51], v161 offset:136
    v_mfma_f32_16x16x32_bf16 v[28:31], v[200:203], v[120:123], v[28:31]
    ds_read_b64 v[52:53], v161 offset:640
    v_mfma_f32_16x16x32_bf16 v[32:35], v[200:203], v[124:127], v[32:35]
    ds_read_b64 v[54:55], v161 offset:648
    v_mfma_f32_16x16x32_bf16 v[24:27], v[204:207], v[112:115], v[24:27]
    ds_read_b64 v[56:57], v161 offset:1152
    v_mfma_f32_16x16x32_bf16 v[28:31], v[204:207], v[116:119], v[28:31]
    ds_read_b64 v[58:59], v161 offset:1160
    v_mfma_f32_16x16x32_bf16 v[32:35], v[204:207], v[120:123], v[32:35]
    ds_read_b64 v[60:61], v161 offset:1664
    v_mfma_f32_16x16x32_bf16 v[36:39], v[204:207], v[124:127], v[36:39]
    ds_read_b64 v[62:63], v161 offset:1672
    v_mfma_f32_16x16x32_bf16 v[28:31], v[208:211], v[112:115], v[28:31]
    ds_read_b64 v[64:65], v161 offset:2176
    v_mfma_f32_16x16x32_bf16 v[32:35], v[208:211], v[116:119], v[32:35]
    ds_read_b64 v[66:67], v161 offset:2184
    v_mfma_f32_16x16x32_bf16 v[36:39], v[208:211], v[120:123], v[36:39]
    ds_read_b64 v[68:69], v161 offset:2688
    v_mfma_f32_16x16x32_bf16 v[40:43], v[208:211], v[124:127], v[40:43]
    ds_read_b64 v[70:71], v161 offset:2696
    v_mfma_f32_16x16x32_bf16 v[32:35], v[212:215], v[112:115], v[32:35]
    ds_read_b64 v[72:73], v161 offset:3200
    v_mfma_f32_16x16x32_bf16 v[36:39], v[212:215], v[116:119], v[36:39]
    ds_read_b64 v[74:75], v161 offset:3208
    v_mfma_f32_16x16x32_bf16 v[40:43], v[212:215], v[120:123], v[40:43]
    ds_read_b64 v[76:77], v161 offset:3712
    v_mfma_f32_16x16x32_bf16 v[44:47], v[212:215], v[124:127], v[44:47]
    ds_read_b64 v[78:79], v161 offset:3720
    v_mfma_f32_16x16x32_bf16 v[36:39], v[216:219], v[112:115], v[36:39]
    v_mfma_f32_16x16x32_bf16 v[44:47], v[216:219], v[120:123], v[44:47]
    v_mfma_f32_16x16x32_bf16 v[40:43], v[216:219], v[116:119], v[40:43]
    v_mfma_f32_16x16x32_bf16 v[44:47], v[220:223], v[116:119], v[44:47]
    v_mfma_f32_16x16x32_bf16 v[40:43], v[220:223], v[112:115], v[40:43]
    v_mfma_f32_16x16x32_bf16 v[44:47], v[224:227], v[112:115], v[44:47]
    s_waitcnt lgkmcnt(0)
    v_mfma_f32_16x16x32_bf16 v[16:19], v[48:51], v[80:83], v[16:19]
    ds_read_b128 v[112:115], v162 offset:3776
    v_mfma_f32_16x16x32_bf16 v[20:23], v[48:51], v[84:87], v[20:23]
    ds_read_b128 v[116:119], v162 offset:3264
    v_mfma_f32_16x16x32_bf16 v[24:27], v[48:51], v[88:91], v[24:27]
    ds_read_b128 v[120:123], v162 offset:2752
    v_mfma_f32_16x16x32_bf16 v[28:31], v[48:51], v[92:95], v[28:31]
    ds_read_b128 v[124:127], v162 offset:2240
    v_mfma_f32_16x16x32_bf16 v[20:23], v[52:55], v[80:83], v[20:23]
    ds_read_b64 v[196:197], v161 offset:192
    v_mfma_f32_16x16x32_bf16 v[24:27], v[52:55], v[84:87], v[24:27]
    ds_read_b64 v[198:199], v161 offset:200
    v_mfma_f32_16x16x32_bf16 v[28:31], v[52:55], v[88:91], v[28:31]
    ds_read_b64 v[200:201], v161 offset:704
    v_mfma_f32_16x16x32_bf16 v[32:35], v[52:55], v[92:95], v[32:35]
    ds_read_b64 v[202:203], v161 offset:712
    v_mfma_f32_16x16x32_bf16 v[24:27], v[56:59], v[80:83], v[24:27]
    ds_read_b64 v[204:205], v161 offset:1216
    v_mfma_f32_16x16x32_bf16 v[28:31], v[56:59], v[84:87], v[28:31]
    ds_read_b64 v[206:207], v161 offset:1224
    v_mfma_f32_16x16x32_bf16 v[32:35], v[56:59], v[88:91], v[32:35]
    ds_read_b64 v[208:209], v161 offset:1728
    v_mfma_f32_16x16x32_bf16 v[36:39], v[56:59], v[92:95], v[36:39]
    ds_read_b64 v[210:211], v161 offset:1736
    v_mfma_f32_16x16x32_bf16 v[28:31], v[60:63], v[80:83], v[28:31]
    ds_read_b64 v[212:213], v161 offset:2240
    v_mfma_f32_16x16x32_bf16 v[32:35], v[60:63], v[84:87], v[32:35]
    ds_read_b64 v[214:215], v161 offset:2248
    v_mfma_f32_16x16x32_bf16 v[36:39], v[60:63], v[88:91], v[36:39]
    ds_read_b64 v[216:217], v161 offset:2752
    v_mfma_f32_16x16x32_bf16 v[40:43], v[60:63], v[92:95], v[40:43]
    ds_read_b64 v[218:219], v161 offset:2760
    v_mfma_f32_16x16x32_bf16 v[32:35], v[64:67], v[80:83], v[32:35]
    ds_read_b64 v[220:221], v161 offset:3264
    v_mfma_f32_16x16x32_bf16 v[36:39], v[64:67], v[84:87], v[36:39]
    ds_read_b64 v[222:223], v161 offset:3272
    v_mfma_f32_16x16x32_bf16 v[40:43], v[64:67], v[88:91], v[40:43]
    ds_read_b64 v[224:225], v161 offset:3776
    v_mfma_f32_16x16x32_bf16 v[44:47], v[64:67], v[92:95], v[44:47]
    ds_read_b64 v[226:227], v161 offset:3784
    v_mfma_f32_16x16x32_bf16 v[36:39], v[68:71], v[80:83], v[36:39]
    v_mfma_f32_16x16x32_bf16 v[44:47], v[68:71], v[88:91], v[44:47]
    v_mfma_f32_16x16x32_bf16 v[40:43], v[68:71], v[84:87], v[40:43]
    s_waitcnt vmcnt(0)
    s_mov_b64 exec, 1
    buffer_store_dword v13, v14, s[32:35], s7 offen sc1
    s_mov_b64 exec, -1
    v_mfma_f32_16x16x32_bf16 v[44:47], v[72:75], v[84:87], v[44:47]
    v_mfma_f32_16x16x32_bf16 v[40:43], v[72:75], v[80:83], v[40:43]
    v_mfma_f32_16x16x32_bf16 v[44:47], v[76:79], v[80:83], v[44:47]
    s_waitcnt lgkmcnt(0)
    v_mfma_f32_16x16x32_bf16 v[16:19], v[196:199], v[112:115], v[16:19]
    ds_read_b128 v[80:83], v162 offset:3840
    v_mfma_f32_16x16x32_bf16 v[20:23], v[196:199], v[116:119], v[20:23]
    ds_read_b128 v[84:87], v162 offset:3328
    v_mfma_f32_16x16x32_bf16 v[24:27], v[196:199], v[120:123], v[24:27]
    ds_read_b128 v[88:91], v162 offset:2816
    v_mfma_f32_16x16x32_bf16 v[28:31], v[196:199], v[124:127], v[28:31]
    ds_read_b128 v[92:95], v162 offset:2304
    v_mfma_f32_16x16x32_bf16 v[20:23], v[200:203], v[112:115], v[20:23]
    ds_read_b64 v[48:49], v161 offset:256
    v_mfma_f32_16x16x32_bf16 v[24:27], v[200:203], v[116:119], v[24:27]
    ds_read_b64 v[50:51], v161 offset:264
    v_mfma_f32_16x16x32_bf16 v[28:31], v[200:203], v[120:123], v[28:31]
    ds_read_b64 v[52:53], v161 offset:768
    v_mfma_f32_16x16x32_bf16 v[32:35], v[200:203], v[124:127], v[32:35]
    ds_read_b64 v[54:55], v161 offset:776
    v_mfma_f32_16x16x32_bf16 v[24:27], v[204:207], v[112:115], v[24:27]
    ds_read_b64 v[56:57], v161 offset:1280
    v_mfma_f32_16x16x32_bf16 v[28:31], v[204:207], v[116:119], v[28:31]
    ds_read_b64 v[58:59], v161 offset:1288
    v_mfma_f32_16x16x32_bf16 v[32:35], v[204:207], v[120:123], v[32:35]
    ds_read_b64 v[60:61], v161 offset:1792
    v_mfma_f32_16x16x32_bf16 v[36:39], v[204:207], v[124:127], v[36:39]
    ds_read_b64 v[62:63], v161 offset:1800
    v_mfma_f32_16x16x32_bf16 v[28:31], v[208:211], v[112:115], v[28:31]
    ds_read_b64 v[64:65], v161 offset:2304
    v_mfma_f32_16x16x32_bf16 v[32:35], v[208:211], v[116:119], v[32:35]
    ds_read_b64 v[66:67], v161 offset:2312
    v_mfma_f32_16x16x32_bf16 v[36:39], v[208:211], v[120:123], v[36:39]
    ds_read_b64 v[68:69], v161 offset:2816
    v_mfma_f32_16x16x32_bf16 v[40:43], v[208:211], v[124:127], v[40:43]
    ds_read_b64 v[70:71], v161 offset:2824
    v_mfma_f32_16x16x32_bf16 v[32:35], v[212:215], v[112:115], v[32:35]
    ds_read_b64 v[72:73], v161 offset:3328
    v_mfma_f32_16x16x32_bf16 v[36:39], v[212:215], v[116:119], v[36:39]
    ds_read_b64 v[74:75], v161 offset:3336
    v_mfma_f32_16x16x32_bf16 v[40:43], v[212:215], v[120:123], v[40:43]
    ds_read_b64 v[76:77], v161 offset:3840
    v_mfma_f32_16x16x32_bf16 v[44:47], v[212:215], v[124:127], v[44:47]
    ds_read_b64 v[78:79], v161 offset:3848
    v_mfma_f32_16x16x32_bf16 v[36:39], v[216:219], v[112:115], v[36:39]
    v_mfma_f32_16x16x32_bf16 v[44:47], v[216:219], v[120:123], v[44:47]
    v_mfma_f32_16x16x32_bf16 v[40:43], v[216:219], v[116:119], v[40:43]
    v_mfma_f32_16x16x32_bf16 v[44:47], v[220:223], v[116:119], v[44:47]
    v_mfma_f32_16x16x32_bf16 v[40:43], v[220:223], v[112:115], v[40:43]
    v_mfma_f32_16x16x32_bf16 v[44:47], v[224:227], v[112:115], v[44:47]
    s_waitcnt lgkmcnt(0)
    v_mfma_f32_16x16x32_bf16 v[16:19], v[48:51], v[80:83], v[16:19]
    ds_read_b128 v[112:115], v162 offset:3904
    v_mfma_f32_16x16x32_bf16 v[20:23], v[48:51], v[84:87], v[20:23]
    ds_read_b128 v[116:119], v162 offset:3392
    v_mfma_f32_16x16x32_bf16 v[24:27], v[48:51], v[88:91], v[24:27]
    ds_read_b128 v[120:123], v162 offset:2880
    v_mfma_f32_16x16x32_bf16 v[28:31], v[48:51], v[92:95], v[28:31]
    ds_read_b128 v[124:127], v162 offset:2368
    v_mfma_f32_16x16x32_bf16 v[20:23], v[52:55], v[80:83], v[20:23]
    ds_read_b64 v[196:197], v161 offset:320
    v_mfma_f32_16x16x32_bf16 v[24:27], v[52:55], v[84:87], v[24:27]
    ds_read_b64 v[198:199], v161 offset:328
    v_mfma_f32_16x16x32_bf16 v[28:31], v[52:55], v[88:91], v[28:31]
    ds_read_b64 v[200:201], v161 offset:832
    v_mfma_f32_16x16x32_bf16 v[32:35], v[52:55], v[92:95], v[32:35]
    ds_read_b64 v[202:203], v161 offset:840
    v_mfma_f32_16x16x32_bf16 v[24:27], v[56:59], v[80:83], v[24:27]
    ds_read_b64 v[204:205], v161 offset:1344
    v_mfma_f32_16x16x32_bf16 v[28:31], v[56:59], v[84:87], v[28:31]
    ds_read_b64 v[206:207], v161 offset:1352
    v_mfma_f32_16x16x32_bf16 v[32:35], v[56:59], v[88:91], v[32:35]
    ds_read_b64 v[208:209], v161 offset:1856
    v_mfma_f32_16x16x32_bf16 v[36:39], v[56:59], v[92:95], v[36:39]
    ds_read_b64 v[210:211], v161 offset:1864
    v_mfma_f32_16x16x32_bf16 v[28:31], v[60:63], v[80:83], v[28:31]
    ds_read_b64 v[212:213], v161 offset:2368
    v_mfma_f32_16x16x32_bf16 v[32:35], v[60:63], v[84:87], v[32:35]
    ds_read_b64 v[214:215], v161 offset:2376
    v_mfma_f32_16x16x32_bf16 v[36:39], v[60:63], v[88:91], v[36:39]
    ds_read_b64 v[216:217], v161 offset:2880
    v_mfma_f32_16x16x32_bf16 v[40:43], v[60:63], v[92:95], v[40:43]
    ds_read_b64 v[218:219], v161 offset:2888
    v_mfma_f32_16x16x32_bf16 v[32:35], v[64:67], v[80:83], v[32:35]
    ds_read_b64 v[220:221], v161 offset:3392
    v_mfma_f32_16x16x32_bf16 v[36:39], v[64:67], v[84:87], v[36:39]
    ds_read_b64 v[222:223], v161 offset:3400
    v_mfma_f32_16x16x32_bf16 v[40:43], v[64:67], v[88:91], v[40:43]
    ds_read_b64 v[224:225], v161 offset:3904
    v_mfma_f32_16x16x32_bf16 v[44:47], v[64:67], v[92:95], v[44:47]
    ds_read_b64 v[226:227], v161 offset:3912
    v_mfma_f32_16x16x32_bf16 v[36:39], v[68:71], v[80:83], v[36:39]
    v_mfma_f32_16x16x32_bf16 v[44:47], v[68:71], v[88:91], v[44:47]
    v_mfma_f32_16x16x32_bf16 v[40:43], v[68:71], v[84:87], v[40:43]
    v_mfma_f32_16x16x32_bf16 v[44:47], v[72:75], v[84:87], v[44:47]
    v_mfma_f32_16x16x32_bf16 v[40:43], v[72:75], v[80:83], v[40:43]
    v_mfma_f32_16x16x32_bf16 v[44:47], v[76:79], v[80:83], v[44:47]
    s_waitcnt lgkmcnt(0)
    v_mfma_f32_16x16x32_bf16 v[16:19], v[196:199], v[112:115], v[16:19]
    ds_read_b128 v[80:83], v162 offset:3968
    v_mfma_f32_16x16x32_bf16 v[20:23], v[196:199], v[116:119], v[20:23]
    ds_read_b128 v[84:87], v162 offset:3456
    v_mfma_f32_16x16x32_bf16 v[24:27], v[196:199], v[120:123], v[24:27]
    ds_read_b128 v[88:91], v162 offset:2944
    v_mfma_f32_16x16x32_bf16 v[28:31], v[196:199], v[124:127], v[28:31]
    ds_read_b128 v[92:95], v162 offset:2432
    v_mfma_f32_16x16x32_bf16 v[20:23], v[200:203], v[112:115], v[20:23]
    ds_read_b64 v[48:49], v161 offset:384
    v_mfma_f32_16x16x32_bf16 v[24:27], v[200:203], v[116:119], v[24:27]
    ds_read_b64 v[50:51], v161 offset:392
    v_mfma_f32_16x16x32_bf16 v[28:31], v[200:203], v[120:123], v[28:31]
    ds_read_b64 v[52:53], v161 offset:896
    v_mfma_f32_16x16x32_bf16 v[32:35], v[200:203], v[124:127], v[32:35]
    ds_read_b64 v[54:55], v161 offset:904
    v_mfma_f32_16x16x32_bf16 v[24:27], v[204:207], v[112:115], v[24:27]
    ds_read_b64 v[56:57], v161 offset:1408
    v_mfma_f32_16x16x32_bf16 v[28:31], v[204:207], v[116:119], v[28:31]
    ds_read_b64 v[58:59], v161 offset:1416
    v_mfma_f32_16x16x32_bf16 v[32:35], v[204:207], v[120:123], v[32:35]
    ds_read_b64 v[60:61], v161 offset:1920
    v_mfma_f32_16x16x32_bf16 v[36:39], v[204:207], v[124:127], v[36:39]
    ds_read_b64 v[62:63], v161 offset:1928
    v_mfma_f32_16x16x32_bf16 v[28:31], v[208:211], v[112:115], v[28:31]
    ds_read_b64 v[64:65], v161 offset:2432
    v_mfma_f32_16x16x32_bf16 v[32:35], v[208:211], v[116:119], v[32:35]
    ds_read_b64 v[66:67], v161 offset:2440
    v_mfma_f32_16x16x32_bf16 v[36:39], v[208:211], v[120:123], v[36:39]
    ds_read_b64 v[68:69], v161 offset:2944
    v_mfma_f32_16x16x32_bf16 v[40:43], v[208:211], v[124:127], v[40:43]
    ds_read_b64 v[70:71], v161 offset:2952
    v_mfma_f32_16x16x32_bf16 v[32:35], v[212:215], v[112:115], v[32:35]
    ds_read_b64 v[72:73], v161 offset:3456
    v_mfma_f32_16x16x32_bf16 v[36:39], v[212:215], v[116:119], v[36:39]
    ds_read_b64 v[74:75], v161 offset:3464
    v_mfma_f32_16x16x32_bf16 v[40:43], v[212:215], v[120:123], v[40:43]
    ds_read_b64 v[76:77], v161 offset:3968
    v_mfma_f32_16x16x32_bf16 v[44:47], v[212:215], v[124:127], v[44:47]
    ds_read_b64 v[78:79], v161 offset:3976
    v_mfma_f32_16x16x32_bf16 v[36:39], v[216:219], v[112:115], v[36:39]
    v_mfma_f32_16x16x32_bf16 v[44:47], v[216:219], v[120:123], v[44:47]
    v_mfma_f32_16x16x32_bf16 v[40:43], v[216:219], v[116:119], v[40:43]
    v_mfma_f32_16x16x32_bf16 v[44:47], v[220:223], v[116:119], v[44:47]
    v_mfma_f32_16x16x32_bf16 v[40:43], v[220:223], v[112:115], v[40:43]
    v_mfma_f32_16x16x32_bf16 v[44:47], v[224:227], v[112:115], v[44:47]
    s_waitcnt lgkmcnt(0)
    v_mfma_f32_16x16x32_bf16 v[16:19], v[48:51], v[80:83], v[16:19]
    ds_read_b128 v[112:115], v162 offset:4032
    v_mfma_f32_16x16x32_bf16 v[20:23], v[48:51], v[84:87], v[20:23]
    ds_read_b128 v[116:119], v162 offset:3520
    v_mfma_f32_16x16x32_bf16 v[24:27], v[48:51], v[88:91], v[24:27]
    ds_read_b128 v[120:123], v162 offset:3008
    v_mfma_f32_16x16x32_bf16 v[28:31], v[48:51], v[92:95], v[28:31]
    ds_read_b128 v[124:127], v162 offset:2496
    v_mfma_f32_16x16x32_bf16 v[20:23], v[52:55], v[80:83], v[20:23]
    ds_read_b64 v[196:197], v161 offset:448
    v_mfma_f32_16x16x32_bf16 v[24:27], v[52:55], v[84:87], v[24:27]
    ds_read_b64 v[198:199], v161 offset:456
    v_mfma_f32_16x16x32_bf16 v[28:31], v[52:55], v[88:91], v[28:31]
    ds_read_b64 v[200:201], v161 offset:960
    v_mfma_f32_16x16x32_bf16 v[32:35], v[52:55], v[92:95], v[32:35]
    ds_read_b64 v[202:203], v161 offset:968
    v_mfma_f32_16x16x32_bf16 v[24:27], v[56:59], v[80:83], v[24:27]
    ds_read_b64 v[204:205], v161 offset:1472
    v_mfma_f32_16x16x32_bf16 v[28:31], v[56:59], v[84:87], v[28:31]
    ds_read_b64 v[206:207], v161 offset:1480
    v_mfma_f32_16x16x32_bf16 v[32:35], v[56:59], v[88:91], v[32:35]
    ds_read_b64 v[208:209], v161 offset:1984
    v_mfma_f32_16x16x32_bf16 v[36:39], v[56:59], v[92:95], v[36:39]
    ds_read_b64 v[210:211], v161 offset:1992
    v_mfma_f32_16x16x32_bf16 v[28:31], v[60:63], v[80:83], v[28:31]
    ds_read_b64 v[212:213], v161 offset:2496
    v_mfma_f32_16x16x32_bf16 v[32:35], v[60:63], v[84:87], v[32:35]
    ds_read_b64 v[214:215], v161 offset:2504
    v_mfma_f32_16x16x32_bf16 v[36:39], v[60:63], v[88:91], v[36:39]
    ds_read_b64 v[216:217], v161 offset:3008
    v_mfma_f32_16x16x32_bf16 v[40:43], v[60:63], v[92:95], v[40:43]
    ds_read_b64 v[218:219], v161 offset:3016
    v_mfma_f32_16x16x32_bf16 v[32:35], v[64:67], v[80:83], v[32:35]
    ds_read_b64 v[220:221], v161 offset:3520
    v_mfma_f32_16x16x32_bf16 v[36:39], v[64:67], v[84:87], v[36:39]
    ds_read_b64 v[222:223], v161 offset:3528
    v_mfma_f32_16x16x32_bf16 v[40:43], v[64:67], v[88:91], v[40:43]
    ds_read_b64 v[224:225], v161 offset:4032
    v_mfma_f32_16x16x32_bf16 v[44:47], v[64:67], v[92:95], v[44:47]
    ds_read_b64 v[226:227], v161 offset:4040
    v_mfma_f32_16x16x32_bf16 v[36:39], v[68:71], v[80:83], v[36:39]
    v_mfma_f32_16x16x32_bf16 v[44:47], v[68:71], v[88:91], v[44:47]
    v_mfma_f32_16x16x32_bf16 v[40:43], v[68:71], v[84:87], v[40:43]
    v_mfma_f32_16x16x32_bf16 v[44:47], v[72:75], v[84:87], v[44:47]
    v_mfma_f32_16x16x32_bf16 v[40:43], v[72:75], v[80:83], v[40:43]
    v_mfma_f32_16x16x32_bf16 v[44:47], v[76:79], v[80:83], v[44:47]
    s_waitcnt lgkmcnt(0)
    v_mfma_f32_16x16x32_bf16 v[16:19], v[196:199], v[112:115], v[16:19]
    ds_read_b32 v164, v254 offset:0
    ds_read_b64 v[48:49], v161 offset:0
    v_mfma_f32_16x16x32_bf16 v[20:23], v[196:199], v[116:119], v[20:23]
    ds_read_b64 v[50:51], v161 offset:8
    ds_read_b64 v[52:53], v161 offset:512
    v_mfma_f32_16x16x32_bf16 v[24:27], v[196:199], v[120:123], v[24:27]
    ds_read_b64 v[54:55], v161 offset:520
    ds_read_b64 v[56:57], v161 offset:1024
    v_mfma_f32_16x16x32_bf16 v[28:31], v[196:199], v[124:127], v[28:31]
    ds_read_b64 v[58:59], v161 offset:1032
    ds_read_b64 v[60:61], v161 offset:1536
    v_mfma_f32_16x16x32_bf16 v[20:23], v[200:203], v[112:115], v[20:23]
    ds_read_b64 v[62:63], v161 offset:1544
    ds_read_b64 v[64:65], v161 offset:64
    v_mfma_f32_16x16x32_bf16 v[24:27], v[200:203], v[116:119], v[24:27]
    ds_read_b64 v[66:67], v161 offset:72
    ds_read_b64 v[68:69], v161 offset:576
    v_mfma_f32_16x16x32_bf16 v[28:31], v[200:203], v[120:123], v[28:31]
    ds_read_b64 v[70:71], v161 offset:584
    ds_read_b64 v[72:73], v161 offset:1088
    v_mfma_f32_16x16x32_bf16 v[32:35], v[200:203], v[124:127], v[32:35]
    ds_read_b64 v[74:75], v161 offset:1096
    ds_read_b64 v[76:77], v161 offset:1600
    v_mfma_f32_16x16x32_bf16 v[24:27], v[204:207], v[112:115], v[24:27]
    ds_read_b64 v[78:79], v161 offset:1608
    v_mfma_f32_16x16x32_bf16 v[28:31], v[204:207], v[116:119], v[28:31]
    s_waitcnt lgkmcnt(15)
    v_readfirstlane_b32 s60, v164
    s_nop 0
    s_cmp_ge_u32 s60, 4
    s_cbranch_scc0 uhi_slow
uhi_back:
    v_mfma_f32_16x16x32_bf16 v[32:35], v[204:207], v[120:123], v[32:35]
    ds_read_b128 v[80:83], v162 offset:1536
    ds_read_b128 v[84:87], v162 offset:1024
    v_mfma_f32_16x16x32_bf16 v[36:39], v[204:207], v[124:127], v[36:39]
    ds_read_b128 v[88:91], v162 offset:512
    ds_read_b128 v[92:95], v162 offset:0
    v_mfma_f32_16x16x32_bf16 v[28:31], v[208:211], v[112:115], v[28:31]
    ds_read_b128 v[96:99], v162 offset:1600
    ds_read_b128 v[100:103], v162 offset:1088
    v_mfma_f32_16x16x32_bf16 v[32:35], v[208:211], v[116:119], v[32:35]
    ds_read_b128 v[104:107], v162 offset:576
    ds_read_b128 v[108:111], v162 offset:64
    v_mfma_f32_16x16x32_bf16 v[36:39], v[208:211], v[120:123], v[36:39]
    v_cvt_pk_bf16_f32 v172, v16, v17
    v_mfma_f32_16x16x32_bf16 v[40:43], v[208:211], v[124:127], v[40:43]
    v_cvt_pk_bf16_f32 v173, v18, v19
    v_mfma_f32_16x16x32_bf16 v[32:35], v[212:215], v[112:115], v[32:35]
    ds_write_b64 v163, v[172:173] offset:0
    v_mfma_f32_16x16x32_bf16 v[36:39], v[212:215], v[116:119], v[36:39]
    v_cvt_pk_bf16_f32 v174, v20, v21
    v_mfma_f32_16x16x32_bf16 v[40:43], v[212:215], v[120:123], v[40:43]
    v_cvt_pk_bf16_f32 v175, v22, v23
    v_mfma_f32_16x16x32_bf16 v[44:47], v[212:215], v[124:127], v[44:47]
    ds_write_b64 v163, v[174:175] offset:512
    v_mfma_f32_16x16x32_bf16 v[36:39], v[216:219], v[112:115], v[36:39]
    v_cvt_pk_bf16_f32 v176, v24, v25
    v_mfma_f32_16x16x32_bf16 v[44:47], v[216:219], v[120:123], v[44:47]
    v_cvt_pk_bf16_f32 v177, v26, v27
    v_mfma_f32_16x16x32_bf16 v[40:43], v[216:219], v[116:119], v[40:43]
    ds_write_b64 v163, v[176:177] offset:1024
    v_mfma_f32_16x16x32_bf16 v[44:47], v[220:223], v[116:119], v[44:47]
    v_cvt_pk_bf16_f32 v178, v28, v29
    v_mfma_f32_16x16x32_bf16 v[40:43], v[220:223], v[112:115], v[40:43]
    v_cvt_pk_bf16_f32 v179, v30, v31
    v_mfma_f32_16x16x32_bf16 v[44:47], v[224:227], v[112:115], v[44:47]
    ds_write_b64 v163, v[178:179] offset:1536
    s_waitcnt lgkmcnt(8)
    v_mfma_f32_16x16x32_bf16 v[32:35], v[168:171], v[80:83], v[32:35]
    s_mov_b64 exec, 1
    ds_add_u32 v254, v255 offset:20
    s_mov_b64 exec, -1
    v_mfma_f32_16x16x32_bf16 v[44:47], v[168:171], v[92:95], v[44:47]
    ds_read_b128 v[112:115], v162 offset:1664
    ds_read_b128 v[116:119], v162 offset:1152
    v_mfma_f32_16x16x32_bf16 v[36:39], v[168:171], v[84:87], v[36:39]
    ds_read_b128 v[120:123], v162 offset:640
    ds_read_b128 v[124:127], v162 offset:128
    v_mfma_f32_16x16x32_bf16 v[40:43], v[168:171], v[88:91], v[40:43]
    ds_read_b64 v[196:197], v161 offset:128
    v_mfma_f32_16x16x32_bf16 v[44:47], v[60:63], v[80:83], v[44:47]
    ds_read_b64 v[198:199], v161 offset:136
    ds_read_b32 v164, v254 offset:20
    v_mfma_f32_16x16x32_bf16 v[32:35], v[48:51], v[80:83], v[32:35]
    ds_read_b64 v[200:201], v161 offset:640
    v_mfma_f32_16x16x32_bf16 v[44:47], v[56:59], v[84:87], v[44:47]
    ds_read_b64 v[202:203], v161 offset:648
    v_mfma_f32_16x16x32_bf16 v[36:39], v[52:55], v[80:83], v[36:39]
    ds_read_b64 v[204:205], v161 offset:1152
    v_mfma_f32_16x16x32_bf16 v[40:43], v[56:59], v[80:83], v[40:43]
    ds_read_b64 v[206:207], v161 offset:1160
    v_mfma_f32_16x16x32_bf16 v[36:39], v[48:51], v[84:87], v[36:39]
    ds_read_b64 v[208:209], v161 offset:1664
    v_mfma_f32_16x16x32_bf16 v[44:47], v[52:55], v[88:91], v[44:47]
    ds_read_b64 v[210:211], v161 offset:1672
    v_mfma_f32_16x16x32_bf16 v[40:43], v[52:55], v[84:87], v[40:43]
    v_mfma_f32_16x16x32_bf16 v[44:47], v[48:51], v[92:95], v[44:47]
    v_mfma_f32_16x16x32_bf16 v[40:43], v[48:51], v[88:91], v[40:43]
    s_waitcnt lgkmcnt(15)
    v_mfma_f32_16x16x32_bf16 v[44:47], v[76:79], v[96:99], v[44:47]
    s_waitcnt lgkmcnt(6)
    v_readfirstlane_b32 s60, v164
    s_nop 0
    s_cmp_ge_u32 s60, 8
    s_cbranch_scc0 ylo_slow
ylo_back:
    v_mfma_f32_16x16x32_bf16 v[32:35], v[64:67], v[96:99], v[32:35]
    ds_read_b128 v[128:131], v162 offset:1728
    ds_read_b128 v[132:135], v162 offset:1216
    v_mfma_f32_16x16x32_bf16 v[44:47], v[72:75], v[100:103], v[44:47]
    ds_read_b128 v[136:139], v162 offset:704
    ds_read_b128 v[140:143], v162 offset:192
    ds_read_b64 v[212:213], v161 offset:192
    v_mfma_f32_16x16x32_bf16 v[36:39], v[68:71], v[96:99], v[36:39]
    ds_read_b64 v[214:215], v161 offset:200
    ds_read2st64_b32 v[184:185], v180 offset0:0 offset1:16
    v_mfma_f32_16x16x32_bf16 v[40:43], v[72:75], v[96:99], v[40:43]
    ds_read_b64 v[216:217], v161 offset:704
    ds_read2st64_b32 v[186:187], v181 offset0:0 offset1:16
    v_mfma_f32_16x16x32_bf16 v[36:39], v[64:67], v[100:103], v[36:39]
    ds_read_b64 v[218:219], v161 offset:712
    ds_read2st64_b32 v[188:189], v180 offset0:4 offset1:20
    v_mfma_f32_16x16x32_bf16 v[44:47], v[68:71], v[104:107], v[44:47]
    ds_read_b64 v[220:221], v161 offset:1216
    ds_read2st64_b32 v[190:191], v181 offset0:4 offset1:20
    v_mfma_f32_16x16x32_bf16 v[40:43], v[68:71], v[100:103], v[40:43]
    ds_read_b64 v[222:223], v161 offset:1224
    v_mfma_f32_16x16x32_bf16 v[44:47], v[64:67], v[108:111], v[44:47]
    ds_read_b64 v[224:225], v161 offset:1728
    v_mfma_f32_16x16x32_bf16 v[40:43], v[64:67], v[104:107], v[40:43]
    ds_read_b64 v[226:227], v161 offset:1736
    s_waitcnt lgkmcnt(15)
    v_mfma_f32_16x16x32_bf16 v[44:47], v[208:211], v[112:115], v[44:47]
    v_mfma_f32_16x16x32_bf16 v[32:35], v[196:199], v[112:115], v[32:35]
    ds_read_b128 v[80:83], v162 offset:1792
    ds_read_b128 v[84:87], v162 offset:1280
    v_mfma_f32_16x16x32_bf16 v[44:47], v[204:207], v[116:119], v[44:47]
    ds_read_b128 v[88:91], v162 offset:768
    ds_read_b128 v[92:95], v162 offset:256
    ds_read_b64 v[48:49], v161 offset:256
    s_waitcnt lgkmcnt(8)
    buffer_store_dwordx4 v[184:187], v238, s[44:47], s62 offen sc1
    v_mfma_f32_16x16x32_bf16 v[36:39], v[200:203], v[112:115], v[36:39]
    ds_read_b64 v[50:51], v161 offset:264
    buffer_store_dwordx4 v[188:191], v238, s[44:47], s63 offen sc1
    v_mfma_f32_16x16x32_bf16 v[40:43], v[204:207], v[112:115], v[40:43]
    ds_read_b64 v[52:53], v161 offset:768
    v_mfma_f32_16x16x32_bf16 v[36:39], v[196:199], v[116:119], v[36:39]
    ds_read_b64 v[54:55], v161 offset:776
    v_mfma_f32_16x16x32_bf16 v[44:47], v[200:203], v[120:123], v[44:47]
    ds_read_b64 v[56:57], v161 offset:1280
    v_mfma_f32_16x16x32_bf16 v[40:43], v[200:203], v[116:119], v[40:43]
    ds_read_b64 v[58:59], v161 offset:1288
    v_mfma_f32_16x16x32_bf16 v[44:47], v[196:199], v[124:127], v[44:47]
    ds_read_b64 v[60:61], v161 offset:1792
    v_mfma_f32_16x16x32_bf16 v[40:43], v[196:199], v[120:123], v[40:43]
    ds_read_b64 v[62:63], v161 offset:1800
    s_waitcnt lgkmcnt(12)
    v_mfma_f32_16x16x32_bf16 v[44:47], v[224:227], v[128:131], v[44:47]
    v_mfma_f32_16x16x32_bf16 v[32:35], v[212:215], v[128:131], v[32:35]
    ds_read_b128 v[96:99], v162 offset:1856
    ds_read_b128 v[100:103], v162 offset:1344
    v_mfma_f32_16x16x32_bf16 v[44:47], v[220:223], v[132:135], v[44:47]
    ds_read_b128 v[104:107], v162 offset:832
    ds_read_b128 v[108:111], v162 offset:320
    ds_read_b64 v[64:65], v161 offset:320
    v_mfma_f32_16x16x32_bf16 v[36:39], v[216:219], v[128:131], v[36:39]
    ds_read_b64 v[66:67], v161 offset:328
    v_mfma_f32_16x16x32_bf16 v[40:43], v[220:223], v[128:131], v[40:43]
    ds_read_b64 v[68:69], v161 offset:832
    v_mfma_f32_16x16x32_bf16 v[36:39], v[212:215], v[132:135], v[36:39]
    ds_read_b64 v[70:71], v161 offset:840
    v_mfma_f32_16x16x32_bf16 v[44:47], v[216:219], v[136:139], v[44:47]
    ds_read_b64 v[72:73], v161 offset:1344
    v_mfma_f32_16x16x32_bf16 v[40:43], v[216:219], v[132:135], v[40:43]
    ds_read_b64 v[74:75], v161 offset:1352
    v_mfma_f32_16x16x32_bf16 v[44:47], v[212:215], v[140:143], v[44:47]
    ds_read_b64 v[76:77], v161 offset:1856
    v_mfma_f32_16x16x32_bf16 v[40:43], v[212:215], v[136:139], v[40:43]
    ds_read_b64 v[78:79], v161 offset:1864
    s_waitcnt lgkmcnt(12)
    v_mfma_f32_16x16x32_bf16 v[44:47], v[60:63], v[80:83], v[44:47]
    ds_write_b32 v254, v255 offset:24
    buffer_load_dword v249, v248, s[32:35], s71 offen sc1
    v_mfma_f32_16x16x32_bf16 v[32:35], v[48:51], v[80:83], v[32:35]
    ds_read_b128 v[112:115], v162 offset:1920
    ds_read_b128 v[116:119], v162 offset:1408
    v_mfma_f32_16x16x32_bf16 v[44:47], v[56:59], v[84:87], v[44:47]
    ds_read_b128 v[120:123], v162 offset:896
    ds_read_b128 v[124:127], v162 offset:384
    ds_read_b64 v[196:197], v161 offset:384
    v_mfma_f32_16x16x32_bf16 v[36:39], v[52:55], v[80:83], v[36:39]
    ds_read_b64 v[198:199], v161 offset:392
    v_mfma_f32_16x16x32_bf16 v[40:43], v[56:59], v[80:83], v[40:43]
    ds_read_b64 v[200:201], v161 offset:896
    v_mfma_f32_16x16x32_bf16 v[36:39], v[48:51], v[84:87], v[36:39]
    ds_read_b64 v[202:203], v161 offset:904
    v_mfma_f32_16x16x32_bf16 v[44:47], v[52:55], v[88:91], v[44:47]
    ds_read_b64 v[204:205], v161 offset:1408
    v_mfma_f32_16x16x32_bf16 v[40:43], v[52:55], v[84:87], v[40:43]
    ds_read_b64 v[206:207], v161 offset:1416
    v_mfma_f32_16x16x32_bf16 v[44:47], v[48:51], v[92:95], v[44:47]
    ds_read_b64 v[208:209], v161 offset:1920
    v_mfma_f32_16x16x32_bf16 v[40:43], v[48:51], v[88:91], v[40:43]
    ds_read_b64 v[210:211], v161 offset:1928
    s_waitcnt lgkmcnt(13)
    v_mfma_f32_16x16x32_bf16 v[44:47], v[76:79], v[96:99], v[44:47]
    v_mfma_f32_16x16x32_bf16 v[32:35], v[64:67], v[96:99], v[32:35]
    ds_read_b128 v[128:131], v162 offset:1984
    ds_read_b128 v[132:135], v162 offset:1472
    v_mfma_f32_16x16x32_bf16 v[44:47], v[72:75], v[100:103], v[44:47]
    ds_read_b128 v[136:139], v162 offset:960
    ds_read_b128 v[140:143], v162 offset:448
    ds_read_b64 v[212:213], v161 offset:448
    v_mfma_f32_16x16x32_bf16 v[36:39], v[68:71], v[96:99], v[36:39]
    ds_read_b64 v[214:215], v161 offset:456
    v_mfma_f32_16x16x32_bf16 v[40:43], v[72:75], v[96:99], v[40:43]
    ds_read_b64 v[216:217], v161 offset:960
    v_mfma_f32_16x16x32_bf16 v[36:39], v[64:67], v[100:103], v[36:39]
    ds_read_b64 v[218:219], v161 offset:968
    v_mfma_f32_16x16x32_bf16 v[44:47], v[68:71], v[104:107], v[44:47]
    ds_read_b64 v[220:221], v161 offset:1472
    v_mfma_f32_16x16x32_bf16 v[40:43], v[68:71], v[100:103], v[40:43]
    ds_read_b64 v[222:223], v161 offset:1480
    v_mfma_f32_16x16x32_bf16 v[44:47], v[64:67], v[108:111], v[44:47]
    ds_read_b64 v[224:225], v161 offset:1984
    v_mfma_f32_16x16x32_bf16 v[40:43], v[64:67], v[104:107], v[40:43]
    ds_read_b64 v[226:227], v161 offset:1992
    s_waitcnt lgkmcnt(12)
    v_mfma_f32_16x16x32_bf16 v[44:47], v[208:211], v[112:115], v[44:47]
    v_mfma_f32_16x16x32_bf16 v[32:35], v[196:199], v[112:115], v[32:35]
    v_mfma_f32_16x16x32_bf16 v[44:47], v[204:207], v[116:119], v[44:47]
    v_mfma_f32_16x16x32_bf16 v[36:39], v[200:203], v[112:115], v[36:39]
    v_mfma_f32_16x16x32_bf16 v[40:43], v[204:207], v[112:115], v[40:43]
    v_mfma_f32_16x16x32_bf16 v[36:39], v[196:199], v[116:119], v[36:39]
    v_mfma_f32_16x16x32_bf16 v[44:47], v[200:203], v[120:123], v[44:47]
    v_mfma_f32_16x16x32_bf16 v[40:43], v[200:203], v[116:119], v[40:43]
    v_mfma_f32_16x16x32_bf16 v[44:47], v[196:199], v[124:127], v[44:47]
    v_mfma_f32_16x16x32_bf16 v[40:43], v[196:199], v[120:123], v[40:43]
    s_waitcnt lgkmcnt(0)
    v_mfma_f32_16x16x32_bf16 v[44:47], v[224:227], v[128:131], v[44:47]
    v_mfma_f32_16x16x32_bf16 v[32:35], v[212:215], v[128:131], v[32:35]
    v_mfma_f32_16x16x32_bf16 v[44:47], v[220:223], v[132:135], v[44:47]
    v_mfma_f32_16x16x32_bf16 v[36:39], v[216:219], v[128:131], v[36:39]
    v_mfma_f32_16x16x32_bf16 v[40:43], v[220:223], v[128:131], v[40:43]
    v_mfma_f32_16x16x32_bf16 v[36:39], v[212:215], v[132:135], v[36:39]
    v_mfma_f32_16x16x32_bf16 v[44:47], v[216:219], v[136:139], v[44:47]
    v_mfma_f32_16x16x32_bf16 v[40:43], v[216:219], v[132:135], v[40:43]
    v_mfma_f32_16x16x32_bf16 v[44:47], v[212:215], v[140:143], v[44:47]
    v_mfma_f32_16x16x32_bf16 v[40:43], v[212:215], v[136:139], v[40:43]
    v_cvt_pk_bf16_f32 v172, v32, v33
    v_cvt_pk_bf16_f32 v173, v34, v35
    ds_write_b64 v163, v[172:173] offset:2048
    s_nop 0
    v_cvt_pk_bf16_f32 v174, v36, v37
    v_cvt_pk_bf16_f32 v175, v38, v39
    ds_write_b64 v163, v[174:175] offset:2560
    v_cvt_pk_bf16_f32 v178, v44, v45
    v_cvt_pk_bf16_f32 v179, v46, v47
    ds_write_b64 v163, v[178:179] offset:3584
    v_cvt_pk_bf16_f32 v176, v40, v41
    v_cvt_pk_bf16_f32 v177, v42, v43
    ds_write_b64 v163, v[176:177] offset:3072
    s_setprio 2
    s_mov_b64 exec, 1
    ds_add_u32 v254, v255 offset:8
    s_mov_b64 exec, -1
    s_mov_b32 s61, 0
c2_spin:
    ds_read_b32 v166, v254 offset:8
    s_add_u32 s61, s61, 1
    s_waitcnt lgkmcnt(0)
    v_readfirstlane_b32 s60, v166
    s_nop 0
    s_cmp_ge_u32 s60, 4
    s_nop 1
    s_cbranch_scc1 c2_go
    s_cmp_ge_u32 s61, 4194304
    s_cbranch_scc1 c2_go
    s_sleep 1
    s_branch c2_spin
c2_go:
    ds_read2st64_b32 v[164:165], v180 offset0:8 offset1:24
    ds_read2st64_b32 v[166:167], v181 offset0:8 offset1:24
    ds_read2st64_b32 v[168:169], v180 offset0:12 offset1:28
    ds_read2st64_b32 v[170:171], v181 offset0:12 offset1:28
    s_waitcnt lgkmcnt(2)
    buffer_store_dwordx4 v[164:167], v238, s[44:47], s64 offen sc1
    s_waitcnt lgkmcnt(0)
    buffer_store_dwordx4 v[168:171], v238, s[44:47], s65 offen sc1
    s_setprio 0
    s_mov_b64 exec, 1
    ds_add_u32 v254, v255 offset:8
    s_mov_b64 exec, -1
    s_bitcmp0_b32 s2, 0
    s_cbranch_scc0 conv_ffn
    s_waitcnt vmcnt(2)
    s_mov_b64 s[16:17], -1
    v_mov_b32 v140, -1
    s_mov_b64 s[18:19], -1
    v_mov_b32 v144, -1
    s_mov_b64 s[20:21], -1
    v_mov_b32 v148, -1
    s_mov_b64 s[22:23], -1
    v_mov_b32 v152, -1
    s_xor_b32 s24, s3, 0
    s_lshl_b32 s24, s24, 15
    s_add_u32 s25, s24, 8192
    s_add_u32 s26, s24, 16384
    s_add_u32 s27, s24, 24576
    s_mov_b64 s[0:1], -1
    s_cmp_eq_u32 s0, 0
    s_cbranch_scc1 fbk_1
    v_cmp_ne_u32 s[0:1], s8, v249
    s_nop 0
    s_lshr_b32 s9, s0, 0
    v_and_b32 v250, s9, v236
    v_cmp_eq_u32 s[48:49], 0, v250
    s_lshr_b32 s9, s0, 8
    v_and_b32 v250, s9, v236
    v_cmp_eq_u32 s[50:51], 0, v250
    s_lshr_b32 s9, s0, 16
    v_and_b32 v250, s9, v236
    v_cmp_eq_u32 s[52:53], 0, v250
    s_lshr_b32 s9, s0, 24
    v_and_b32 v250, s9, v236
    v_cmp_eq_u32 s[54:55], 0, v250
    s_nop 4
fbk_1:
    s_mov_b32 exec_lo, s0
    s_mov_b32 exec_hi, 0
    s_cbranch_execz yf_2
    buffer_load_dword v249, v248, s[32:35], s6 offen sc1
yf_2:
    s_and_b64 exec, s[16:17], s[48:49]
    s_cbranch_execz yi_3
    buffer_load_dwordx4 v[140:143], v251, s[44:47], s24 offen sc1
yi_3:
    s_and_b64 exec, s[18:19], s[50:51]
    s_cbranch_execz yi_4
    buffer_load_dwordx4 v[144:147], v251, s[44:47], s25 offen sc1
yi_4:
    s_and_b64 exec, s[20:21], s[52:53]
    s_cbranch_execz yi_5
    buffer_load_dwordx4 v[148:151], v251, s[44:47], s26 offen sc1
yi_5:
    s_and_b64 exec, s[22:23], s[54:55]
    s_cbranch_execz yi_6
    buffer_load_dwordx4 v[152:155], v251, s[44:47], s27 offen sc1
yi_6:
    s_mov_b64 exec, -1
    s_nop 0
yf_skip:
    s_mov_b32 s61, 0
xr_7_spin:
    ds_read_b32 v3, v254 offset:12
    s_add_u32 s61, s61, 1
    s_waitcnt lgkmcnt(0)
    v_readfirstlane_b32 s60, v3
    s_nop 0
    s_cmp_ge_u32 s60, 8
    s_nop 1
    s_cbranch_scc1 xr_7_go
    s_cmp_ge_u32 s61, 4194304
    s_cbranch_scc1 xr_7_go
    s_sleep 1
    s_branch xr_7_spin
xr_7_go:
    ds_read_b64 v[76:77], v229 offset:0
    ds_read_b64 v[78:79], v229 offset:512
    ds_read_b64 v[80:81], v229 offset:1024
    ds_read_b64 v[82:83], v229 offset:1536
    ds_read_b64 v[84:85], v229 offset:2064
    ds_read_b64 v[86:87], v229 offset:2576
    ds_read_b64 v[88:89], v229 offset:3088
    ds_read_b64 v[90:91], v229 offset:3600
    ds_read_b64 v[92:93], v230 offset:0
    ds_read_b64 v[94:95], v230 offset:512
    ds_read_b64 v[96:97], v230 offset:1024
    ds_read_b64 v[98:99], v230 offset:1536
    v_mov_b64 v[116:117], 0
    v_mov_b64 v[118:119], 0
    v_mov_b64 v[120:121], 0
    v_mov_b64 v[122:123], 0
    v_mov_b64 v[124:125], 0
    v_mov_b64 v[126:127], 0
    s_mov_b32 s72, 0
    s_waitcnt lgkmcnt(8)
    v_lshlrev_b32 v4, 16, v76
    v_and_b32 v5, 0xffff0000, v76
    v_lshlrev_b32 v6, 16, v77
    v_and_b32 v7, 0xffff0000, v77
    v_lshlrev_b32 v8, 16, v78
    v_and_b32 v9, 0xffff0000, v78
    v_lshlrev_b32 v10, 16, v79
    v_and_b32 v11, 0xffff0000, v79
    v_lshlrev_b32 v12, 16, v80
    v_and_b32 v13, 0xffff0000, v80
    v_lshlrev_b32 v14, 16, v81
    v_and_b32 v15, 0xffff0000, v81
    v_lshlrev_b32 v16, 16, v82
    v_and_b32 v17, 0xffff0000, v82
    v_lshlrev_b32 v18, 16, v83
    v_and_b32 v19, 0xffff0000, v83
    s_waitcnt lgkmcnt(4)
    v_lshlrev_b32 v20, 16, v84
    v_and_b32 v21, 0xffff0000, v84
    v_lshlrev_b32 v22, 16, v85
    v_and_b32 v23, 0xffff0000, v85
    v_lshlrev_b32 v24, 16, v86
    v_and_b32 v25, 0xffff0000, v86
    v_lshlrev_b32 v26, 16, v87
    v_and_b32 v27, 0xffff0000, v87
    v_lshlrev_b32 v28, 16, v88
    v_and_b32 v29, 0xffff0000, v88
    v_lshlrev_b32 v30, 16, v89
    v_and_b32 v31, 0xffff0000, v89
    v_lshlrev_b32 v32, 16, v90
    v_and_b32 v33, 0xffff0000, v90
    v_lshlrev_b32 v34, 16, v91
    v_and_b32 v35, 0xffff0000, v91
    s_waitcnt lgkmcnt(0)
    v_lshlrev_b32 v100, 16, v92
    v_and_b32 v101, 0xffff0000, v92
    v_lshlrev_b32 v102, 16, v93
    v_and_b32 v103, 0xffff0000, v93
    v_lshlrev_b32 v104, 16, v94
    v_and_b32 v105, 0xffff0000, v94
    v_lshlrev_b32 v106, 16, v95
    v_and_b32 v107, 0xffff0000, v95
    v_lshlrev_b32 v108, 16, v96
    v_and_b32 v109, 0xffff0000, v96
    v_lshlrev_b32 v110, 16, v97
    v_and_b32 v111, 0xffff0000, v97
    v_lshlrev_b32 v112, 16, v98
    v_and_b32 v113, 0xffff0000, v98
    v_lshlrev_b32 v114, 16, v99
    v_and_b32 v115, 0xffff0000, v99
    s_mov_b32 s61, 0
    s_nop 0
xs_8_spin:
    ds_read_b32 v3, v254 offset:28
    s_add_u32 s61, s61, 1
    s_waitcnt lgkmcnt(0)
    v_readfirstlane_b32 s60, v3
    s_nop 0
    s_cmp_ge_u32 s60, 4
    s_nop 1
    s_cbranch_scc1 xs_8_go
    s_cmp_ge_u32 s61, 4194304
    s_cbranch_scc1 xs_8_go
    s_sleep 1
    s_branch xs_8_spin
xs_8_go:
    ds_read_b128 v[128:131], v231 offset:0
    ds_read_b128 v[132:135], v231 offset:16
    ds_read_b32 v3, v254 offset:48
    s_waitcnt lgkmcnt(2)
    v_pk_fma_f32 v[36:37], v[4:5], v[130:131], v[128:129]
    v_pk_fma_f32 v[38:39], v[6:7], v[130:131], v[128:129]
    v_pk_fma_f32 v[40:41], v[8:9], v[130:131], v[128:129]
    v_pk_fma_f32 v[42:43], v[10:11], v[130:131], v[128:129]
    v_pk_fma_f32 v[44:45], v[12:13], v[130:131], v[128:129]
    v_pk_fma_f32 v[46:47], v[14:15], v[130:131], v[128:129]
    v_pk_fma_f32 v[48:49], v[16:17], v[130:131], v[128:129]
    v_pk_fma_f32 v[50:51], v[18:19], v[130:131], v[128:129]
    s_waitcnt lgkmcnt(1)
    v_pk_fma_f32 v[52:53], v[20:21], v[134:135], v[132:133]
    v_pk_fma_f32 v[54:55], v[22:23], v[134:135], v[132:133]
    v_pk_fma_f32 v[56:57], v[24:25], v[134:135], v[132:133]
    v_pk_fma_f32 v[58:59], v[26:27], v[134:135], v[132:133]
    v_pk_fma_f32 v[60:61], v[28:29], v[134:135], v[132:133]
    v_pk_fma_f32 v[62:63], v[30:31], v[134:135], v[132:133]
    v_pk_fma_f32 v[64:65], v[32:33], v[134:135], v[132:133]
    v_pk_fma_f32 v[66:67], v[34:35], v[134:135], v[132:133]
    s_waitcnt lgkmcnt(0)
    v_readfirstlane_b32 s71, v3
    s_nop 3
    s_branch rows
uhi_slow:
    s_nop 7
    s_mov_b32 s61, 0
uhi_spin:
    ds_read_b32 v164, v254 offset:0
    s_add_u32 s61, s61, 1
    s_waitcnt lgkmcnt(0)
    v_readfirstlane_b32 s60, v164
    s_nop 0
    s_cmp_ge_u32 s60, 4
    s_nop 1
    s_cbranch_scc1 uhi_go
    s_cmp_ge_u32 s61, 4194304
    s_cbranch_scc1 uhi_go
    s_sleep 1
    s_branch uhi_spin
uhi_go:
    s_branch uhi_back
ylo_slow:
    s_nop 7
    s_mov_b32 s61, 0
ylo_spin:
    ds_read_b32 v164, v254 offset:20
    s_add_u32 s61, s61, 1
    s_waitcnt lgkmcnt(0)
    v_readfirstlane_b32 s60, v164
    s_nop 0
    s_cmp_ge_u32 s60, 8
    s_nop 1
    s_cbranch_scc1 ylo_go
    s_cmp_ge_u32 s61, 4194304
    s_cbranch_scc1 ylo_go
    s_sleep 1
    s_branch ylo_spin
ylo_go:
    s_branch ylo_back
helper:
    s_waitcnt vmcnt(1)
    ds_write_b128 v165, v[120:123] offset:256
    s_waitcnt vmcnt(0)
    ds_write_b128 v165, v[124:127] offset:0
    s_mov_b64 exec, 1
    ds_add_u32 v254, v255 offset:0
    s_mov_b64 exec, -1
    s_mov_b32 s61, 0
uw_spin:
    ds_read_b32 v28, v254 offset:12
    s_add_u32 s61, s61, 1
    s_waitcnt lgkmcnt(0)
    v_readfirstlane_b32 s60, v28
    s_nop 0
    s_cmp_ge_u32 s60, 4
    s_nop 1
    s_cbranch_scc1 uw_go
    s_cmp_ge_u32 s61, 4194304
    s_cbranch_scc1 uw_go
    s_sleep 1
    s_branch uw_spin
uw_go:
    s_lshl_b32 s61, s3, 14
    s_bitcmp0_b32 s2, 0
    s_cbranch_scc0 helper_ffn
    s_add_u32 s62, s61, 2097152
    s_add_u32 s63, s61, 2101248
    s_add_u32 s79, s61, 4194304
    s_lshr_b32 s78, s3, 4
    s_lshl_b32 s78, s78, 20
    s_and_b32 s60, s3, 15
    s_lshl_b32 s60, s60, 14
    s_add_u32 s78, s78, s60
    s_add_u32 s70, s69, 4096
    buffer_load_dwordx4 v[68:71], v2, s[36:39], s69 offen offset:0 nt
    buffer_load_dwordx4 v[72:75], v2, s[36:39], s69 offen offset:1024 nt
    buffer_load_dwordx4 v[76:79], v2, s[36:39], s69 offen offset:2048 nt
    buffer_load_dwordx4 v[80:83], v2, s[36:39], s69 offen offset:3072 nt
    buffer_load_dwordx4 v[84:87], v2, s[36:39], s70 offen offset:0 nt
    buffer_load_dwordx4 v[88:91], v2, s[36:39], s70 offen offset:1024 nt
    buffer_load_dwordx4 v[92:95], v2, s[36:39], s70 offen offset:2048 nt
    buffer_load_dwordx4 v[96:99], v2, s[36:39], s70 offen offset:3072 nt
    buffer_load_dwordx4 v[100:103], v2, s[40:43], 0 offen offset:0
    buffer_load_dwordx4 v[104:107], v2, s[40:43], 0 offen offset:1024
    s_mov_b32 s61, 0
ru0_spin:
    ds_read_b32 v3, v254 offset:0
    s_add_u32 s61, s61, 1
    s_waitcnt lgkmcnt(0)
    v_readfirstlane_b32 s60, v3
    s_nop 0
    s_cmp_ge_u32 s60, 4
    s_nop 1
    s_cbranch_scc1 ru0_go
    s_cmp_ge_u32 s61, 4194304
    s_cbranch_scc1 ru0_go
    s_sleep 1
    s_branch ru0_spin
ru0_go:
    s_mov_b32 s61, 0
ru1_spin:
    ds_read_b32 v3, v254 offset:12
    s_add_u32 s61, s61, 1
    s_waitcnt lgkmcnt(0)
    v_readfirstlane_b32 s60, v3
    s_nop 0
    s_cmp_ge_u32 s60, 4
    s_nop 1
    s_cbranch_scc1 ru1_go
    s_cmp_ge_u32 s61, 4194304
    s_cbranch_scc1 ru1_go
    s_sleep 1
    s_branch ru1_spin
ru1_go:
    buffer_store_dwordx4 v[240:243], v237, s[32:35], s62 offen sc1
    buffer_store_dwordx4 v[240:243], v237, s[32:35], s63 offen sc1
    buffer_store_dwordx4 v[240:243], v237, s[32:35], s79 offen sc1
    s_add_u32 s60, s79, 4096
    buffer_store_dwordx4 v[240:243], v237, s[32:35], s60 offen
    s_mov_b32 s72, 0x3f803f80
    s_mov_b32 s73, 0x3a800000
    s_lshl_b32 s6, s12, 10
    s_add_u32 s6, s6, 196608
    s_mov_b64 s[16:17], -1
    s_mov_b64 s[18:19], -1
    s_mov_b64 s[20:21], -1
    s_mov_b64 s[22:23], -1
    s_xor_b32 s24, s3, 0
    s_lshl_b32 s24, s24, 15
    s_add_u32 s25, s24, 8192
    s_add_u32 s26, s24, 16384
    s_add_u32 s27, s24, 24576
    s_mov_b64 s[0:1], -1
    s_waitcnt vmcnt(4)
    s_mov_b32 s61, 0
late_spin:
    ds_read_b32 v3, v254 offset:24
    s_add_u32 s61, s61, 1
    s_waitcnt lgkmcnt(0)
    v_readfirstlane_b32 s60, v3
    s_nop 0
    s_cmp_ge_u32 s60, 1
    s_nop 1
    s_cbranch_scc1 late_go
    s_cmp_ge_u32 s61, 4194304
    s_cbranch_scc1 late_go
    s_sleep 6
    s_branch late_spin
late_go:
    buffer_load_dword v249, v248, s[32:35], s6 offen sc1
    buffer_load_dwordx2 v[156:157], v253, s[56:59], s78 offen offset:0 nt
    buffer_load_dwordx2 v[158:159], v253, s[56:59], s78 offen offset:2048 nt
    s_add_u32 s78, s78, 4096
    buffer_load_dwordx2 v[160:161], v253, s[56:59], s78 offen offset:0 nt
    buffer_load_dwordx2 v[162:163], v253, s[56:59], s78 offen offset:2048 nt
    s_add_u32 s78, s78, 4096
d_early_done:
    s_mov_b32 s61, 0
mf1_spin:
    ds_read_b32 v3, v254 offset:8
    s_add_u32 s61, s61, 1
    s_waitcnt lgkmcnt(0)
    v_readfirstlane_b32 s60, v3
    s_nop 0
    s_cmp_ge_u32 s60, 4
    s_nop 1
    s_cbranch_scc1 mf1_go
    s_cmp_ge_u32 s61, 4194304
    s_cbranch_scc1 mf1_go
    s_sleep 1
    s_branch mf1_spin
mf1_go:
    s_setprio 1
    ds_write_b128 v235, v[68:71] offset:0
    ds_write_b128 v235, v[72:75] offset:1024
    ds_write_b128 v235, v[76:79] offset:2064
    ds_write_b128 v235, v[80:83] offset:3088
    ds_write_b128 v235, v[84:87] offset:4128
    ds_write_b128 v235, v[88:91] offset:5152
    ds_write_b128 v235, v[92:95] offset:6192
    ds_write_b128 v235, v[96:99] offset:7216
    ds_write_b128 v239, v[100:103] offset:0
    ds_write_b128 v239, v[104:107] offset:1024
    s_mov_b64 exec, 1
    ds_add_u32 v254, v255 offset:12
    s_mov_b64 exec, -1
    v_dot2_f32_bf16 v36, v68, s72, 0
    v_dot2_f32_bf16 v40, v68, v68, 0
    v_dot2_f32_bf16 v37, v76, s72, 0
    v_dot2_f32_bf16 v41, v76, v76, 0
    v_dot2_f32_bf16 v38, v84, s72, 0
    v_dot2_f32_bf16 v42, v84, v84, 0
    v_dot2_f32_bf16 v39, v92, s72, 0
    v_dot2_f32_bf16 v43, v92, v92, 0
    v_dot2_f32_bf16 v44, v100, s72, 0
    v_dot2_f32_bf16 v36, v69, s72, v36
    v_dot2_f32_bf16 v40, v69, v69, v40
    v_dot2_f32_bf16 v37, v77, s72, v37
    v_dot2_f32_bf16 v41, v77, v77, v41
    v_dot2_f32_bf16 v38, v85, s72, v38
    v_dot2_f32_bf16 v42, v85, v85, v42
    v_dot2_f32_bf16 v39, v93, s72, v39
    v_dot2_f32_bf16 v43, v93, v93, v43
    v_dot2_f32_bf16 v44, v101, s72, v44
    v_dot2_f32_bf16 v36, v70, s72, v36
    v_dot2_f32_bf16 v40, v70, v70, v40
    v_dot2_f32_bf16 v37, v78, s72, v37
    v_dot2_f32_bf16 v41, v78, v78, v41
    v_dot2_f32_bf16 v38, v86, s72, v38
    v_dot2_f32_bf16 v42, v86, v86, v42
    v_dot2_f32_bf16 v39, v94, s72, v39
    v_dot2_f32_bf16 v43, v94, v94, v43
    v_dot2_f32_bf16 v44, v102, s72, v44
    v_dot2_f32_bf16 v36, v71, s72, v36
    v_dot2_f32_bf16 v40, v71, v71, v40
    v_dot2_f32_bf16 v37, v79, s72, v37
    v_dot2_f32_bf16 v41, v79, v79, v41
    v_dot2_f32_bf16 v38, v87, s72, v38
    v_dot2_f32_bf16 v42, v87, v87, v42
    v_dot2_f32_bf16 v39, v95, s72, v39
    v_dot2_f32_bf16 v43, v95, v95, v43
    v_dot2_f32_bf16 v44, v103, s72, v44
    v_dot2_f32_bf16 v36, v72, s72, v36
    v_dot2_f32_bf16 v40, v72, v72, v40
    v_dot2_f32_bf16 v37, v80, s72, v37
    v_dot2_f32_bf16 v41, v80, v80, v41
    v_dot2_f32_bf16 v38, v88, s72, v38
    v_dot2_f32_bf16 v42, v88, v88, v42
    v_dot2_f32_bf16 v39, v96, s72, v39
    v_dot2_f32_bf16 v43, v96, v96, v43
    v_dot2_f32_bf16 v44, v104, s72, v44
    v_dot2_f32_bf16 v36, v73, s72, v36
    v_dot2_f32_bf16 v40, v73, v73, v40
    v_dot2_f32_bf16 v37, v81, s72, v37
    v_dot2_f32_bf16 v41, v81, v81, v41
    v_dot2_f32_bf16 v38, v89, s72, v38
    v_dot2_f32_bf16 v42, v89, v89, v42
    v_dot2_f32_bf16 v39, v97, s72, v39
    v_dot2_f32_bf16 v43, v97, v97, v43
    v_dot2_f32_bf16 v44, v105, s72, v44
    v_dot2_f32_bf16 v36, v74, s72, v36
    v_dot2_f32_bf16 v40, v74, v74, v40
    v_dot2_f32_bf16 v37, v82, s72, v37
    v_dot2_f32_bf16 v41, v82, v82, v41
    v_dot2_f32_bf16 v38, v90, s72, v38
    v_dot2_f32_bf16 v42, v90, v90, v42
    v_dot2_f32_bf16 v39, v98, s72, v39
    v_dot2_f32_bf16 v43, v98, v98, v43
    v_dot2_f32_bf16 v44, v106, s72, v44
    v_dot2_f32_bf16 v36, v75, s72, v36
    v_dot2_f32_bf16 v40, v75, v75, v40
    v_dot2_f32_bf16 v37, v83, s72, v37
    v_dot2_f32_bf16 v41, v83, v83, v41
    v_dot2_f32_bf16 v38, v91, s72, v38
    v_dot2_f32_bf16 v42, v91, v91, v42
    v_dot2_f32_bf16 v39, v99, s72, v39
    v_dot2_f32_bf16 v43, v99, v99, v43
    v_dot2_f32_bf16 v44, v107, s72, v44
    v_permlane32_swap_b32 v36, v37
    v_permlane32_swap_b32 v38, v39
    v_permlane32_swap_b32 v40, v41
    v_permlane32_swap_b32 v42, v43
    v_add_f32 v36, v36, v37
    v_add_f32 v38, v38, v39
    v_add_f32 v40, v40, v41
    v_add_f32 v42, v42, v43
    v_permlane16_swap_b32 v36, v38
    s_nop 0
    v_permlane16_swap_b32 v40, v42
    v_add_f32 v36, v36, v38
    v_add_f32 v40, v40, v42
    s_nop 0
    v_add_f32_dpp v36, v36, v36 row_shr:1 row_mask:0xf bank_mask:0xf bound_ctrl:0
    v_add_f32_dpp v40, v40, v40 row_shr:1 row_mask:0xf bank_mask:0xf bound_ctrl:0
    v_add_f32_dpp v44, v44, v44 row_shr:1 row_mask:0xf bank_mask:0xf bound_ctrl:0
    v_add_f32_dpp v36, v36, v36 row_shr:2 row_mask:0xf bank_mask:0xf bound_ctrl:0
    v_add_f32_dpp v40, v40, v40 row_shr:2 row_mask:0xf bank_mask:0xf bound_ctrl:0
    v_add_f32_dpp v44, v44, v44 row_shr:2 row_mask:0xf bank_mask:0xf bound_ctrl:0
    v_add_f32_dpp v36, v36, v36 row_shr:4 row_mask:0xf bank_mask:0xf bound_ctrl:0
    v_add_f32_dpp v40, v40, v40 row_shr:4 row_mask:0xf bank_mask:0xf bound_ctrl:0
    v_add_f32_dpp v44, v44, v44 row_shr:4 row_mask:0xf bank_mask:0xf bound_ctrl:0
    v_add_f32_dpp v36, v36, v36 row_shr:8 row_mask:0xf bank_mask:0xf bound_ctrl:0
    v_add_f32_dpp v40, v40, v40 row_shr:8 row_mask:0xf bank_mask:0xf bound_ctrl:0
    v_add_f32_dpp v44, v44, v44 row_shr:8 row_mask:0xf bank_mask:0xf bound_ctrl:0
    s_nop 1
    v_add_f32_dpp v44, v44, v44 row_bcast:15 row_mask:0xa bank_mask:0xf
    v_mul_f32 v36, s73, v36
    s_nop 0
    v_add_f32_dpp v44, v44, v44 row_bcast:31 row_mask:0xc bank_mask:0xf
    v_mul_f32 v37, v36, v36
    v_fma_f32 v40, v40, s73, -v37
    v_max_f32 v40, 0, v40
    v_cvt_pk_bf16_f32 v36, 0, v36
    v_cvt_pk_bf16_f32 v40, 0, v40
    v_add_f32 v40, 0x3727c5ac, v40
    v_cvt_pk_bf16_f32 v40, 0, v40
    v_sqrt_f32 v40, v40
    s_nop 0
    v_cvt_pk_bf16_f32 v40, 0, v40
    v_rcp_f32 v50, v40
    v_rcp_f32 v51, v40
    v_mul_f32 v48, -v36, v50
    v_mul_f32 v49, -v36, v50
    s_mov_b32 exec_lo, 0x80008000
    s_mov_b32 exec_hi, 0x80008000
    ds_write_b128 v244, v[48:51]
    s_mov_b32 exec_lo, 0
    s_mov_b32 exec_hi, 0x80000000
    ds_write_b32 v254, v44 offset:48
    s_mov_b64 exec, 1
    ds_add_u32 v254, v255 offset:28
    s_mov_b64 exec, -1
    s_setprio 0
    s_waitcnt vmcnt(4)
    s_cmp_eq_u32 s0, 0
    s_cbranch_scc1 fbk_9
    v_cmp_ne_u32 s[0:1], s8, v249
    s_nop 0
    s_lshr_b32 s9, s0, 0
    v_and_b32 v250, s9, v236
    v_cmp_eq_u32 s[48:49], 0, v250
    s_lshr_b32 s9, s0, 8
    v_and_b32 v250, s9, v236
    v_cmp_eq_u32 s[50:51], 0, v250
    s_lshr_b32 s9, s0, 16
    v_and_b32 v250, s9, v236
    v_cmp_eq_u32 s[52:53], 0, v250
    s_lshr_b32 s9, s0, 24
    v_and_b32 v250, s9, v236
    v_cmp_eq_u32 s[54:55], 0, v250
    s_nop 4
fbk_9:
    s_mov_b32 s61, 0
mf_spin:
    ds_read_b32 v3, v254 offset:8
    s_add_u32 s61, s61, 1
    s_waitcnt lgkmcnt(0)
    v_readfirstlane_b32 s60, v3
    s_nop 0
    s_cmp_ge_u32 s60, 8
    s_nop 1
    s_cbranch_scc1 mf_go
    s_cmp_ge_u32 s61, 4194304
    s_cbranch_scc1 mf_go
    s_sleep 1
    s_branch mf_spin
mf_go:
    s_mov_b32 exec_lo, s0
    s_mov_b32 exec_hi, 0
    s_cbranch_execz yf_10
    buffer_load_dword v249, v248, s[32:35], s6 offen sc1
yf_10:
    s_and_b64 exec, s[16:17], s[48:49]
    s_cbranch_execz yi_11
    buffer_load_dwordx4 v[140:143], v251, s[44:47], s24 offen sc1
yi_11:
    s_and_b64 exec, s[18:19], s[50:51]
    s_cbranch_execz yi_12
    buffer_load_dwordx4 v[144:147], v251, s[44:47], s25 offen sc1
yi_12:
    s_and_b64 exec, s[20:21], s[52:53]
    s_cbranch_execz yi_13
    buffer_load_dwordx4 v[148:151], v251, s[44:47], s26 offen sc1
yi_13:
    s_and_b64 exec, s[22:23], s[54:55]
    s_cbranch_execz yi_14
    buffer_load_dwordx4 v[152:155], v251, s[44:47], s27 offen sc1
yi_14:
    s_mov_b64 exec, -1
    s_nop 0
yf_skip2:
    s_mov_b32 s61, 0
xr_15_spin:
    ds_read_b32 v3, v254 offset:12
    s_add_u32 s61, s61, 1
    s_waitcnt lgkmcnt(0)
    v_readfirstlane_b32 s60, v3
    s_nop 0
    s_cmp_ge_u32 s60, 8
    s_nop 1
    s_cbranch_scc1 xr_15_go
    s_cmp_ge_u32 s61, 4194304
    s_cbranch_scc1 xr_15_go
    s_sleep 1
    s_branch xr_15_spin
xr_15_go:
    ds_read_b64 v[76:77], v229 offset:0
    ds_read_b64 v[78:79], v229 offset:512
    ds_read_b64 v[80:81], v229 offset:1024
    ds_read_b64 v[82:83], v229 offset:1536
    ds_read_b64 v[84:85], v229 offset:2064
    ds_read_b64 v[86:87], v229 offset:2576
    ds_read_b64 v[88:89], v229 offset:3088
    ds_read_b64 v[90:91], v229 offset:3600
    ds_read_b64 v[92:93], v230 offset:0
    ds_read_b64 v[94:95], v230 offset:512
    ds_read_b64 v[96:97], v230 offset:1024
    ds_read_b64 v[98:99], v230 offset:1536
    v_mov_b64 v[116:117], 0
    v_mov_b64 v[118:119], 0
    v_mov_b64 v[120:121], 0
    v_mov_b64 v[122:123], 0
    v_mov_b64 v[124:125], 0
    v_mov_b64 v[126:127], 0
    s_mov_b32 s72, 0
    s_waitcnt lgkmcnt(8)
    v_lshlrev_b32 v4, 16, v76
    v_and_b32 v5, 0xffff0000, v76
    v_lshlrev_b32 v6, 16, v77
    v_and_b32 v7, 0xffff0000, v77
    v_lshlrev_b32 v8, 16, v78
    v_and_b32 v9, 0xffff0000, v78
    v_lshlrev_b32 v10, 16, v79
    v_and_b32 v11, 0xffff0000, v79
    v_lshlrev_b32 v12, 16, v80
    v_and_b32 v13, 0xffff0000, v80
    v_lshlrev_b32 v14, 16, v81
    v_and_b32 v15, 0xffff0000, v81
    v_lshlrev_b32 v16, 16, v82
    v_and_b32 v17, 0xffff0000, v82
    v_lshlrev_b32 v18, 16, v83
    v_and_b32 v19, 0xffff0000, v83
    s_waitcnt lgkmcnt(4)
    v_lshlrev_b32 v20, 16, v84
    v_and_b32 v21, 0xffff0000, v84
    v_lshlrev_b32 v22, 16, v85
    v_and_b32 v23, 0xffff0000, v85
    v_lshlrev_b32 v24, 16, v86
    v_and_b32 v25, 0xffff0000, v86
    v_lshlrev_b32 v26, 16, v87
    v_and_b32 v27, 0xffff0000, v87
    v_lshlrev_b32 v28, 16, v88
    v_and_b32 v29, 0xffff0000, v88
    v_lshlrev_b32 v30, 16, v89
    v_and_b32 v31, 0xffff0000, v89
    v_lshlrev_b32 v32, 16, v90
    v_and_b32 v33, 0xffff0000, v90
    v_lshlrev_b32 v34, 16, v91
    v_and_b32 v35, 0xffff0000, v91
    s_waitcnt lgkmcnt(0)
    v_lshlrev_b32 v100, 16, v92
    v_and_b32 v101, 0xffff0000, v92
    v_lshlrev_b32 v102, 16, v93
    v_and_b32 v103, 0xffff0000, v93
    v_lshlrev_b32 v104, 16, v94
    v_and_b32 v105, 0xffff0000, v94
    v_lshlrev_b32 v106, 16, v95
    v_and_b32 v107, 0xffff0000, v95
    v_lshlrev_b32 v108, 16, v96
    v_and_b32 v109, 0xffff0000, v96
    v_lshlrev_b32 v110, 16, v97
    v_and_b32 v111, 0xffff0000, v97
    v_lshlrev_b32 v112, 16, v98
    v_and_b32 v113, 0xffff0000, v98
    v_lshlrev_b32 v114, 16, v99
    v_and_b32 v115, 0xffff0000, v99
    s_mov_b32 s61, 0
    s_nop 0
xs_16_spin:
    ds_read_b32 v3, v254 offset:28
    s_add_u32 s61, s61, 1
    s_waitcnt lgkmcnt(0)
    v_readfirstlane_b32 s60, v3
    s_nop 0
    s_cmp_ge_u32 s60, 4
    s_nop 1
    s_cbranch_scc1 xs_16_go
    s_cmp_ge_u32 s61, 4194304
    s_cbranch_scc1 xs_16_go
    s_sleep 1
    s_branch xs_16_spin
xs_16_go:
    ds_read_b128 v[128:131], v231 offset:0
    ds_read_b128 v[132:135], v231 offset:16
    ds_read_b32 v3, v254 offset:48
    s_waitcnt lgkmcnt(2)
    v_pk_fma_f32 v[36:37], v[4:5], v[130:131], v[128:129]
    v_pk_fma_f32 v[38:39], v[6:7], v[130:131], v[128:129]
    v_pk_fma_f32 v[40:41], v[8:9], v[130:131], v[128:129]
    v_pk_fma_f32 v[42:43], v[10:11], v[130:131], v[128:129]
    v_pk_fma_f32 v[44:45], v[12:13], v[130:131], v[128:129]
    v_pk_fma_f32 v[46:47], v[14:15], v[130:131], v[128:129]
    v_pk_fma_f32 v[48:49], v[16:17], v[130:131], v[128:129]
    v_pk_fma_f32 v[50:51], v[18:19], v[130:131], v[128:129]
    s_waitcnt lgkmcnt(1)
    v_pk_fma_f32 v[52:53], v[20:21], v[134:135], v[132:133]
    v_pk_fma_f32 v[54:55], v[22:23], v[134:135], v[132:133]
    v_pk_fma_f32 v[56:57], v[24:25], v[134:135], v[132:133]
    v_pk_fma_f32 v[58:59], v[26:27], v[134:135], v[132:133]
    v_pk_fma_f32 v[60:61], v[28:29], v[134:135], v[132:133]
    v_pk_fma_f32 v[62:63], v[30:31], v[134:135], v[132:133]
    v_pk_fma_f32 v[64:65], v[32:33], v[134:135], v[132:133]
    v_pk_fma_f32 v[66:67], v[34:35], v[134:135], v[132:133]
    s_waitcnt lgkmcnt(0)
    v_readfirstlane_b32 s71, v3
    s_nop 4
rows:
    s_mov_b32 s61, 0
py_top:
    s_waitcnt vmcnt(0)
    s_cmp_eq_u32 s0, 0
    s_cbranch_scc1 fbk_17
    v_cmp_ne_u32 s[0:1], s8, v249
    s_nop 0
    s_lshr_b32 s9, s0, 0
    v_and_b32 v250, s9, v236
    v_cmp_eq_u32 s[48:49], 0, v250
    s_lshr_b32 s9, s0, 8
    v_and_b32 v250, s9, v236
    v_cmp_eq_u32 s[50:51], 0, v250
    s_lshr_b32 s9, s0, 16
    v_and_b32 v250, s9, v236
    v_cmp_eq_u32 s[52:53], 0, v250
    s_lshr_b32 s9, s0, 24
    v_and_b32 v250, s9, v236
    v_cmp_eq_u32 s[54:55], 0, v250
    s_nop 4
fbk_17:
    v_max3_u32 v250, v140, v141, v142
    v_max_u32 v250, v250, v143
    v_cmp_eq_u32 s[16:17], -1, v250
    v_max3_u32 v250, v144, v145, v146
    v_max_u32 v250, v250, v147
    v_cmp_eq_u32 s[18:19], -1, v250
    v_max3_u32 v250, v148, v149, v150
    v_max_u32 v250, v250, v151
    v_cmp_eq_u32 s[20:21], -1, v250
    v_max3_u32 v250, v152, v153, v154
    v_max_u32 v250, v250, v155
    v_cmp_eq_u32 s[22:23], -1, v250
    s_or_b64 s[28:29], s[16:17], s[18:19]
    s_or_b64 s[30:31], s[20:21], s[22:23]
    s_or_b64 s[28:29], s[28:29], s[30:31]
    s_nop 0
    s_cbranch_scc0 py_ok
    s_add_u32 s61, s61, 1
    s_cmp_ge_u32 s61, 65536
    s_cbranch_scc1 py_give
    s_mov_b32 exec_lo, s0
    s_mov_b32 exec_hi, 0
    s_cbranch_execz yf_18
    buffer_load_dword v249, v248, s[32:35], s6 offen sc1
yf_18:
    s_and_b64 exec, s[16:17], s[48:49]
    s_cbranch_execz yi_19
    buffer_load_dwordx4 v[140:143], v251, s[44:47], s24 offen sc1
yi_19:
    s_and_b64 exec, s[18:19], s[50:51]
    s_cbranch_execz yi_20
    buffer_load_dwordx4 v[144:147], v251, s[44:47], s25 offen sc1
yi_20:
    s_and_b64 exec, s[20:21], s[52:53]
    s_cbranch_execz yi_21
    buffer_load_dwordx4 v[148:151], v251, s[44:47], s26 offen sc1
yi_21:
    s_and_b64 exec, s[22:23], s[54:55]
    s_cbranch_execz yi_22
    buffer_load_dwordx4 v[152:155], v251, s[44:47], s27 offen sc1
yi_22:
    s_mov_b64 exec, -1
    s_bitcmp1_b32 s72, 0
    s_cbranch_scc1 yd_23
    s_cmp_eq_u64 s[16:17], 0
    s_cbranch_scc0 yd_23
    s_bitset1_b32 s72, 0
    v_lshlrev_b32 v68, 16, v140
    v_and_b32 v72, 0xffff0000, v140
    v_lshlrev_b32 v69, 16, v141
    v_and_b32 v73, 0xffff0000, v141
    v_lshlrev_b32 v70, 16, v142
    v_and_b32 v74, 0xffff0000, v142
    v_lshlrev_b32 v71, 16, v143
    v_and_b32 v75, 0xffff0000, v143
    v_pk_fma_f32 v[4:5], v[68:69], v[36:37], v[4:5]
    v_pk_fma_f32 v[6:7], v[70:71], v[38:39], v[6:7]
    v_pk_fma_f32 v[20:21], v[72:73], v[52:53], v[20:21]
    v_pk_fma_f32 v[22:23], v[74:75], v[54:55], v[22:23]
    v_pk_add_f32 v[116:117], v[116:117], v[4:5]
    v_pk_fma_f32 v[118:119], v[4:5], v[4:5], v[118:119]
    v_pk_fma_f32 v[120:121], v[4:5], v[100:101], v[120:121]
    v_pk_add_f32 v[122:123], v[122:123], v[20:21]
    v_pk_fma_f32 v[124:125], v[20:21], v[20:21], v[124:125]
    v_pk_fma_f32 v[126:127], v[20:21], v[100:101], v[126:127]
    v_pk_add_f32 v[116:117], v[116:117], v[6:7]
    v_pk_fma_f32 v[118:119], v[6:7], v[6:7], v[118:119]
    v_pk_fma_f32 v[120:121], v[6:7], v[102:103], v[120:121]
    v_pk_add_f32 v[122:123], v[122:123], v[22:23]
    v_pk_fma_f32 v[124:125], v[22:23], v[22:23], v[124:125]
    v_pk_fma_f32 v[126:127], v[22:23], v[102:103], v[126:127]
    s_nop 1
yd_23:
    s_bitcmp1_b32 s72, 1
    s_cbranch_scc1 yd_24
    s_cmp_eq_u64 s[18:19], 0
    s_cbranch_scc0 yd_24
    s_bitset1_b32 s72, 1
    v_lshlrev_b32 v68, 16, v144
    v_and_b32 v72, 0xffff0000, v144
    v_lshlrev_b32 v69, 16, v145
    v_and_b32 v73, 0xffff0000, v145
    v_lshlrev_b32 v70, 16, v146
    v_and_b32 v74, 0xffff0000, v146
    v_lshlrev_b32 v71, 16, v147
    v_and_b32 v75, 0xffff0000, v147
    v_pk_fma_f32 v[8:9], v[68:69], v[40:41], v[8:9]
    v_pk_fma_f32 v[10:11], v[70:71], v[42:43], v[10:11]
    v_pk_fma_f32 v[24:25], v[72:73], v[56:57], v[24:25]
    v_pk_fma_f32 v[26:27], v[74:75], v[58:59], v[26:27]
    v_pk_add_f32 v[116:117], v[116:117], v[8:9]
    v_pk_fma_f32 v[118:119], v[8:9], v[8:9], v[118:119]
    v_pk_fma_f32 v[120:121], v[8:9], v[104:105], v[120:121]
    v_pk_add_f32 v[122:123], v[122:123], v[24:25]
    v_pk_fma_f32 v[124:125], v[24:25], v[24:25], v[124:125]
    v_pk_fma_f32 v[126:127], v[24:25], v[104:105], v[126:127]
    v_pk_add_f32 v[116:117], v[116:117], v[10:11]
    v_pk_fma_f32 v[118:119], v[10:11], v[10:11], v[118:119]
    v_pk_fma_f32 v[120:121], v[10:11], v[106:107], v[120:121]
    v_pk_add_f32 v[122:123], v[122:123], v[26:27]
    v_pk_fma_f32 v[124:125], v[26:27], v[26:27], v[124:125]
    v_pk_fma_f32 v[126:127], v[26:27], v[106:107], v[126:127]
    s_nop 1
yd_24:
    s_bitcmp1_b32 s72, 2
    s_cbranch_scc1 yd_25
    s_cmp_eq_u64 s[20:21], 0
    s_cbranch_scc0 yd_25
    s_bitset1_b32 s72, 2
    v_lshlrev_b32 v68, 16, v148
    v_and_b32 v72, 0xffff0000, v148
    v_lshlrev_b32 v69, 16, v149
    v_and_b32 v73, 0xffff0000, v149
    v_lshlrev_b32 v70, 16, v150
    v_and_b32 v74, 0xffff0000, v150
    v_lshlrev_b32 v71, 16, v151
    v_and_b32 v75, 0xffff0000, v151
    v_pk_fma_f32 v[12:13], v[68:69], v[44:45], v[12:13]
    v_pk_fma_f32 v[14:15], v[70:71], v[46:47], v[14:15]
    v_pk_fma_f32 v[28:29], v[72:73], v[60:61], v[28:29]
    v_pk_fma_f32 v[30:31], v[74:75], v[62:63], v[30:31]
    v_pk_add_f32 v[116:117], v[116:117], v[12:13]
    v_pk_fma_f32 v[118:119], v[12:13], v[12:13], v[118:119]
    v_pk_fma_f32 v[120:121], v[12:13], v[108:109], v[120:121]
    v_pk_add_f32 v[122:123], v[122:123], v[28:29]
    v_pk_fma_f32 v[124:125], v[28:29], v[28:29], v[124:125]
    v_pk_fma_f32 v[126:127], v[28:29], v[108:109], v[126:127]
    v_pk_add_f32 v[116:117], v[116:117], v[14:15]
    v_pk_fma_f32 v[118:119], v[14:15], v[14:15], v[118:119]
    v_pk_fma_f32 v[120:121], v[14:15], v[110:111], v[120:121]
    v_pk_add_f32 v[122:123], v[122:123], v[30:31]
    v_pk_fma_f32 v[124:125], v[30:31], v[30:31], v[124:125]
    v_pk_fma_f32 v[126:127], v[30:31], v[110:111], v[126:127]
    s_nop 1
yd_25:
    s_bitcmp1_b32 s72, 3
    s_cbranch_scc1 yd_26
    s_cmp_eq_u64 s[22:23], 0
    s_cbranch_scc0 yd_26
    s_bitset1_b32 s72, 3
    v_lshlrev_b32 v68, 16, v152
    v_and_b32 v72, 0xffff0000, v152
    v_lshlrev_b32 v69, 16, v153
    v_and_b32 v73, 0xffff0000, v153
    v_lshlrev_b32 v70, 16, v154
    v_and_b32 v74, 0xffff0000, v154
    v_lshlrev_b32 v71, 16, v155
    v_and_b32 v75, 0xffff0000, v155
    v_pk_fma_f32 v[16:17], v[68:69], v[48:49], v[16:17]
    v_pk_fma_f32 v[18:19], v[70:71], v[50:51], v[18:19]
    v_pk_fma_f32 v[32:33], v[72:73], v[64:65], v[32:33]
    v_pk_fma_f32 v[34:35], v[74:75], v[66:67], v[34:35]
    v_pk_add_f32 v[116:117], v[116:117], v[16:17]
    v_pk_fma_f32 v[118:119], v[16:17], v[16:17], v[118:119]
    v_pk_fma_f32 v[120:121], v[16:17], v[112:113], v[120:121]
    v_pk_add_f32 v[122:123], v[122:123], v[32:33]
    v_pk_fma_f32 v[124:125], v[32:33], v[32:33], v[124:125]
    v_pk_fma_f32 v[126:127], v[32:33], v[112:113], v[126:127]
    v_pk_add_f32 v[116:117], v[116:117], v[18:19]
    v_pk_fma_f32 v[118:119], v[18:19], v[18:19], v[118:119]
    v_pk_fma_f32 v[120:121], v[18:19], v[114:115], v[120:121]
    v_pk_add_f32 v[122:123], v[122:123], v[34:35]
    v_pk_fma_f32 v[124:125], v[34:35], v[34:35], v[124:125]
    v_pk_fma_f32 v[126:127], v[34:35], v[114:115], v[126:127]
    s_nop 1
yd_26:
    s_branch py_top
py_give:
    s_mov_b64 s[16:17], 0
    s_mov_b64 s[18:19], 0
    s_mov_b64 s[20:21], 0
    s_mov_b64 s[22:23], 0
py_ok:
    s_bitcmp1_b32 s72, 0
    s_cbranch_scc1 yd_27
    s_cmp_eq_u64 s[16:17], 0
    s_cbranch_scc0 yd_27
    s_bitset1_b32 s72, 0
    v_lshlrev_b32 v68, 16, v140
    v_and_b32 v72, 0xffff0000, v140
    v_lshlrev_b32 v69, 16, v141
    v_and_b32 v73, 0xffff0000, v141
    v_lshlrev_b32 v70, 16, v142
    v_and_b32 v74, 0xffff0000, v142
    v_lshlrev_b32 v71, 16, v143
    v_and_b32 v75, 0xffff0000, v143
    v_pk_fma_f32 v[4:5], v[68:69], v[36:37], v[4:5]
    v_pk_fma_f32 v[6:7], v[70:71], v[38:39], v[6:7]
    v_pk_fma_f32 v[20:21], v[72:73], v[52:53], v[20:21]
    v_pk_fma_f32 v[22:23], v[74:75], v[54:55], v[22:23]
    v_pk_add_f32 v[116:117], v[116:117], v[4:5]
    v_pk_fma_f32 v[118:119], v[4:5], v[4:5], v[118:119]
    v_pk_fma_f32 v[120:121], v[4:5], v[100:101], v[120:121]
    v_pk_add_f32 v[122:123], v[122:123], v[20:21]
    v_pk_fma_f32 v[124:125], v[20:21], v[20:21], v[124:125]
    v_pk_fma_f32 v[126:127], v[20:21], v[100:101], v[126:127]
    v_pk_add_f32 v[116:117], v[116:117], v[6:7]
    v_pk_fma_f32 v[118:119], v[6:7], v[6:7], v[118:119]
    v_pk_fma_f32 v[120:121], v[6:7], v[102:103], v[120:121]
    v_pk_add_f32 v[122:123], v[122:123], v[22:23]
    v_pk_fma_f32 v[124:125], v[22:23], v[22:23], v[124:125]
    v_pk_fma_f32 v[126:127], v[22:23], v[102:103], v[126:127]
    s_nop 1
yd_27:
    s_bitcmp1_b32 s72, 1
    s_cbranch_scc1 yd_28
    s_cmp_eq_u64 s[18:19], 0
    s_cbranch_scc0 yd_28
    s_bitset1_b32 s72, 1
    v_lshlrev_b32 v68, 16, v144
    v_and_b32 v72, 0xffff0000, v144
    v_lshlrev_b32 v69, 16, v145
    v_and_b32 v73, 0xffff0000, v145
    v_lshlrev_b32 v70, 16, v146
    v_and_b32 v74, 0xffff0000, v146
    v_lshlrev_b32 v71, 16, v147
    v_and_b32 v75, 0xffff0000, v147
    v_pk_fma_f32 v[8:9], v[68:69], v[40:41], v[8:9]
    v_pk_fma_f32 v[10:11], v[70:71], v[42:43], v[10:11]
    v_pk_fma_f32 v[24:25], v[72:73], v[56:57], v[24:25]
    v_pk_fma_f32 v[26:27], v[74:75], v[58:59], v[26:27]
    v_pk_add_f32 v[116:117], v[116:117], v[8:9]
    v_pk_fma_f32 v[118:119], v[8:9], v[8:9], v[118:119]
    v_pk_fma_f32 v[120:121], v[8:9], v[104:105], v[120:121]
    v_pk_add_f32 v[122:123], v[122:123], v[24:25]
    v_pk_fma_f32 v[124:125], v[24:25], v[24:25], v[124:125]
    v_pk_fma_f32 v[126:127], v[24:25], v[104:105], v[126:127]
    v_pk_add_f32 v[116:117], v[116:117], v[10:11]
    v_pk_fma_f32 v[118:119], v[10:11], v[10:11], v[118:119]
    v_pk_fma_f32 v[120:121], v[10:11], v[106:107], v[120:121]
    v_pk_add_f32 v[122:123], v[122:123], v[26:27]
    v_pk_fma_f32 v[124:125], v[26:27], v[26:27], v[124:125]
    v_pk_fma_f32 v[126:127], v[26:27], v[106:107], v[126:127]
    s_nop 1
yd_28:
    s_bitcmp1_b32 s72, 2
    s_cbranch_scc1 yd_29
    s_cmp_eq_u64 s[20:21], 0
    s_cbranch_scc0 yd_29
    s_bitset1_b32 s72, 2
    v_lshlrev_b32 v68, 16, v148
    v_and_b32 v72, 0xffff0000, v148
    v_lshlrev_b32 v69, 16, v149
    v_and_b32 v73, 0xffff0000, v149
    v_lshlrev_b32 v70, 16, v150
    v_and_b32 v74, 0xffff0000, v150
    v_lshlrev_b32 v71, 16, v151
    v_and_b32 v75, 0xffff0000, v151
    v_pk_fma_f32 v[12:13], v[68:69], v[44:45], v[12:13]
    v_pk_fma_f32 v[14:15], v[70:71], v[46:47], v[14:15]
    v_pk_fma_f32 v[28:29], v[72:73], v[60:61], v[28:29]
    v_pk_fma_f32 v[30:31], v[74:75], v[62:63], v[30:31]
    v_pk_add_f32 v[116:117], v[116:117], v[12:13]
    v_pk_fma_f32 v[118:119], v[12:13], v[12:13], v[118:119]
    v_pk_fma_f32 v[120:121], v[12:13], v[108:109], v[120:121]
    v_pk_add_f32 v[122:123], v[122:123], v[28:29]
    v_pk_fma_f32 v[124:125], v[28:29], v[28:29], v[124:125]
    v_pk_fma_f32 v[126:127], v[28:29], v[108:109], v[126:127]
    v_pk_add_f32 v[116:117], v[116:117], v[14:15]
    v_pk_fma_f32 v[118:119], v[14:15], v[14:15], v[118:119]
    v_pk_fma_f32 v[120:121], v[14:15], v[110:111], v[120:121]
    v_pk_add_f32 v[122:123], v[122:123], v[30:31]
    v_pk_fma_f32 v[124:125], v[30:31], v[30:31], v[124:125]
    v_pk_fma_f32 v[126:127], v[30:31], v[110:111], v[126:127]
    s_nop 1
yd_29:
    s_bitcmp1_b32 s72, 3
    s_cbranch_scc1 yd_30
    s_cmp_eq_u64 s[22:23], 0
    s_cbranch_scc0 yd_30
    s_bitset1_b32 s72, 3
    v_lshlrev_b32 v68, 16, v152
    v_and_b32 v72, 0xffff0000, v152
    v_lshlrev_b32 v69, 16, v153
    v_and_b32 v73, 0xffff0000, v153
    v_lshlrev_b32 v70, 16, v154
    v_and_b32 v74, 0xffff0000, v154
    v_lshlrev_b32 v71, 16, v155
    v_and_b32 v75, 0xffff0000, v155
    v_pk_fma_f32 v[16:17], v[68:69], v[48:49], v[16:17]
    v_pk_fma_f32 v[18:19], v[70:71], v[50:51], v[18:19]
    v_pk_fma_f32 v[32:33], v[72:73], v[64:65], v[32:33]
    v_pk_fma_f32 v[34:35], v[74:75], v[66:67], v[34:35]
    v_pk_add_f32 v[116:117], v[116:117], v[16:17]
    v_pk_fma_f32 v[118:119], v[16:17], v[16:17], v[118:119]
    v_pk_fma_f32 v[120:121], v[16:17], v[112:113], v[120:121]
    v_pk_add_f32 v[122:123], v[122:123], v[32:33]
    v_pk_fma_f32 v[124:125], v[32:33], v[32:33], v[124:125]
    v_pk_fma_f32 v[126:127], v[32:33], v[112:113], v[126:127]
    v_pk_add_f32 v[116:117], v[116:117], v[18:19]
    v_pk_fma_f32 v[118:119], v[18:19], v[18:19], v[118:119]
    v_pk_fma_f32 v[120:121], v[18:19], v[114:115], v[120:121]
    v_pk_add_f32 v[122:123], v[122:123], v[34:35]
    v_pk_fma_f32 v[124:125], v[34:35], v[34:35], v[124:125]
    v_pk_fma_f32 v[126:127], v[34:35], v[114:115], v[126:127]
    s_nop 1
yd_30:
    s_mov_b32 s73, 0x3a800000
    v_add_f32 v68, v116, v117
    v_add_f32 v69, v118, v119
    v_add_f32 v70, v120, v121
    v_add_f32 v72, v122, v123
    v_add_f32 v73, v124, v125
    v_add_f32 v74, v126, v127
    v_permlane32_swap_b32 v68, v72
    v_permlane32_swap_b32 v69, v73
    v_permlane32_swap_b32 v70, v74
    v_add_f32 v68, v68, v72
    v_add_f32 v69, v69, v73
    v_add_f32 v70, v70, v74
    v_add_f32_dpp v68, v68, v68 row_ror:8 row_mask:0xf bank_mask:0xf
    v_add_f32_dpp v69, v69, v69 row_ror:8 row_mask:0xf bank_mask:0xf
    v_add_f32_dpp v70, v70, v70 row_ror:8 row_mask:0xf bank_mask:0xf
    s_mov_b32 exec_lo, 0x00ff00ff
    s_mov_b32 exec_hi, 0x00ff00ff
    ds_write_b128 v234, v[68:71]
    s_mov_b64 exec, -1
    s_lshl_b32 s60, s3, 7
    s_add_u32 s60, s60, 0
    s_cmp_eq_u32 s12, 0
    s_cselect_b32 s60, s60, 0x40000000
    s_cbranch_scc0 no_prio
    s_setprio 3
no_prio:
    s_waitcnt lgkmcnt(0)
    s_barrier
    s_cmp_eq_u32 s14, 0
    s_cbranch_scc1 nodl_31
    buffer_load_dwordx2 v[164:165], v253, s[56:59], s78 offen offset:0 nt
    buffer_load_dwordx2 v[166:167], v253, s[56:59], s78 offen offset:2048 nt
    s_add_u32 s78, s78, 4096
    buffer_load_dwordx2 v[168:169], v253, s[56:59], s78 offen offset:0 nt
    buffer_load_dwordx2 v[170:171], v253, s[56:59], s78 offen offset:2048 nt
    s_add_u32 s78, s78, 249856
    buffer_load_dwordx2 v[172:173], v253, s[56:59], s78 offen offset:0 nt
    buffer_load_dwordx2 v[174:175], v253, s[56:59], s78 offen offset:2048 nt
    s_add_u32 s78, s78, 4096
    buffer_load_dwordx2 v[176:177], v253, s[56:59], s78 offen offset:0 nt
    buffer_load_dwordx2 v[178:179], v253, s[56:59], s78 offen offset:2048 nt
    s_add_u32 s78, s78, 4096
nodl_31:
    ds_read_b128 v[76:79], v233 offset:0
    ds_read_b128 v[80:83], v233 offset:16
    ds_read_b128 v[84:87], v233 offset:32
    ds_read_b128 v[88:91], v233 offset:48
    v_mov_b32 v123, s8
    v_mov_b32 v121, 0
    s_waitcnt lgkmcnt(2)
    v_pk_add_f32 v[76:77], v[76:77], v[80:81]
    v_add_f32 v78, v78, v82
    s_waitcnt lgkmcnt(0)
    v_pk_add_f32 v[84:85], v[84:85], v[88:89]
    v_add_f32 v86, v86, v90
    v_pk_add_f32 v[76:77], v[76:77], v[84:85]
    v_add_f32 v78, v78, v86
    v_mov_b32 v80, v76
    v_mov_b32 v81, v77
    v_mov_b32 v82, v78
    v_permlane32_swap_b32 v76, v80
    v_permlane32_swap_b32 v77, v81
    v_permlane32_swap_b32 v78, v82
    v_pk_add_f32 v[76:77], v[76:77], v[80:81]
    v_add_f32 v78, v78, v82
    v_mov_b32 v80, v76
    v_mov_b32 v81, v77
    v_mov_b32 v82, v78
    v_permlane16_swap_b32 v76, v80
    v_permlane16_swap_b32 v77, v81
    v_permlane16_swap_b32 v78, v82
    v_pk_add_f32 v[76:77], v[76:77], v[80:81]
    v_add_f32 v78, v78, v82
    v_mul_f32 v76, s73, v76
    v_mul_f32 v79, v76, v76
    v_fma_f32 v85, v77, s73, -v79
    v_cvt_pk_bf16_f32 v84, 0, v76
    v_max_f32 v85, 0, v85
    v_cvt_pk_bf16_f32 v85, 0, v85
    v_fma_f32 v78, -v84, s71, v78
    v_add_f32 v85, 0x3727c5ac, v85
    v_cvt_pk_bf16_f32 v85, 0, v85
    v_sqrt_f32 v85, v85
    s_nop 0
    v_cvt_pk_bf16_f32 v85, 0, v85
    v_rcp_f32 v85, v85
    s_nop 0
    v_mul_f32 v78, v78, v85
    v_cvt_pk_bf16_f32 v78, 0, v78
    v_ashrrev_i32 v79, 31, v78
    v_and_b32 v79, 0x7fff0000, v79
    v_xor_b32 v78, 0x80000000, v78
    v_xor_b32 v78, v78, v79
    v_or_b32 v122, v78, v232
    s_nop 1
    v_max_u32_dpp v122, v122, v122 row_ror:1 row_mask:0xf bank_mask:0xf
    s_nop 1
    v_max_u32_dpp v122, v122, v122 row_ror:2 row_mask:0xf bank_mask:0xf
    s_nop 1
    v_max_u32_dpp v122, v122, v122 row_ror:4 row_mask:0xf bank_mask:0xf
    s_nop 1
    v_max_u32_dpp v122, v122, v122 row_ror:8 row_mask:0xf bank_mask:0xf
    s_mov_b64 exec, 1
    buffer_store_dwordx2 v[122:123], v121, s[32:35], s60 offen sc1
    s_mov_b64 exec, -1
    s_setprio 0
    v_readfirstlane_b32 s76, v122
    v_mov_b32 v80, v84
    v_mul_f32 v84, -v84, v85
    v_mov_b32_dpp v87, v85 row_ror:8 row_mask:0xf bank_mask:0xf
    s_nop 0
    v_mov_b32_dpp v86, v84 row_ror:8 row_mask:0xf bank_mask:0xf
    s_mov_b32 vcc_lo, 0xff00ff00
    s_mov_b32 vcc_hi, 0xff00ff00
    v_cndmask_b32 v88, v84, v86, vcc
    v_cndmask_b32 v92, v86, v84, vcc
    v_cndmask_b32 v89, v84, v86, vcc
    v_cndmask_b32 v93, v86, v84, vcc
    v_cndmask_b32 v90, v85, v87, vcc
    v_cndmask_b32 v94, v87, v85, vcc
    v_cndmask_b32 v91, v85, v87, vcc
    v_cndmask_b32 v95, v87, v85, vcc
    s_lshl_b32 s77, s3, 14
    s_add_u32 s77, s77, 2097152
    s_not_b32 s64, s76
    s_bfe_u32 s65, s64, 0x30001
    s_mov_b32 s66, 0x01010101
    s_lshl_b32 s66, s66, s65
    s_mov_b32 s67, s66
    s_bitcmp1_b32 s64, 0
    s_cbranch_scc1 order10
    s_mov_b64 exec, s[66:67]
    v_pk_fma_f32 v[36:37], v[4:5], v[90:91], v[88:89]
    v_pk_fma_f32 v[38:39], v[6:7], v[90:91], v[88:89]
    v_pk_fma_f32 v[40:41], v[8:9], v[90:91], v[88:89]
    v_pk_fma_f32 v[42:43], v[10:11], v[90:91], v[88:89]
    v_pk_fma_f32 v[44:45], v[12:13], v[90:91], v[88:89]
    v_pk_fma_f32 v[46:47], v[14:15], v[90:91], v[88:89]
    v_pk_fma_f32 v[48:49], v[16:17], v[90:91], v[88:89]
    v_pk_fma_f32 v[50:51], v[18:19], v[90:91], v[88:89]
    v_cvt_pk_bf16_f32 v140, v36, v37
    v_cvt_pk_bf16_f32 v141, v38, v39
    v_cvt_pk_bf16_f32 v142, v40, v41
    v_cvt_pk_bf16_f32 v143, v42, v43
    v_cvt_pk_bf16_f32 v144, v44, v45
    v_cvt_pk_bf16_f32 v145, v46, v47
    v_cvt_pk_bf16_f32 v146, v48, v49
    v_cvt_pk_bf16_f32 v147, v50, v51
    buffer_store_dwordx2 v[140:141], v228, s[32:35], s77 offen offset:0 sc1
    buffer_store_dwordx2 v[142:143], v228, s[32:35], s77 offen offset:512 sc1
    buffer_store_dwordx2 v[144:145], v228, s[32:35], s77 offen offset:1024 sc1
    buffer_store_dwordx2 v[146:147], v228, s[32:35], s77 offen offset:1536 sc1
    v_cvt_pk_bf16_f32 v100, v4, v5
    v_cvt_pk_bf16_f32 v101, v6, v7
    v_cvt_pk_bf16_f32 v102, v8, v9
    v_cvt_pk_bf16_f32 v103, v10, v11
    v_cvt_pk_bf16_f32 v104, v12, v13
    v_cvt_pk_bf16_f32 v105, v14, v15
    v_cvt_pk_bf16_f32 v106, v16, v17
    v_cvt_pk_bf16_f32 v107, v18, v19
    s_nop 0
    s_branch cand_done
order10:
    s_mov_b64 exec, s[66:67]
    v_pk_fma_f32 v[36:37], v[20:21], v[94:95], v[92:93]
    v_pk_fma_f32 v[38:39], v[22:23], v[94:95], v[92:93]
    v_pk_fma_f32 v[40:41], v[24:25], v[94:95], v[92:93]
    v_pk_fma_f32 v[42:43], v[26:27], v[94:95], v[92:93]
    v_pk_fma_f32 v[44:45], v[28:29], v[94:95], v[92:93]
    v_pk_fma_f32 v[46:47], v[30:31], v[94:95], v[92:93]
    v_pk_fma_f32 v[48:49], v[32:33], v[94:95], v[92:93]
    v_pk_fma_f32 v[50:51], v[34:35], v[94:95], v[92:93]
    v_cvt_pk_bf16_f32 v140, v36, v37
    v_cvt_pk_bf16_f32 v141, v38, v39
    v_cvt_pk_bf16_f32 v142, v40, v41
    v_cvt_pk_bf16_f32 v143, v42, v43
    v_cvt_pk_bf16_f32 v144, v44, v45
    v_cvt_pk_bf16_f32 v145, v46, v47
    v_cvt_pk_bf16_f32 v146, v48, v49
    v_cvt_pk_bf16_f32 v147, v50, v51
    buffer_store_dwordx2 v[140:141], v228, s[32:35], s77 offen offset:0 sc1
    buffer_store_dwordx2 v[142:143], v228, s[32:35], s77 offen offset:512 sc1
    buffer_store_dwordx2 v[144:145], v228, s[32:35], s77 offen offset:1024 sc1
    buffer_store_dwordx2 v[146:147], v228, s[32:35], s77 offen offset:1536 sc1
    v_cvt_pk_bf16_f32 v100, v20, v21
    v_cvt_pk_bf16_f32 v101, v22, v23
    v_cvt_pk_bf16_f32 v102, v24, v25
    v_cvt_pk_bf16_f32 v103, v26, v27
    v_cvt_pk_bf16_f32 v104, v28, v29
    v_cvt_pk_bf16_f32 v105, v30, v31
    v_cvt_pk_bf16_f32 v106, v32, v33
    v_cvt_pk_bf16_f32 v107, v34, v35
    s_nop 1
cand_done:
    ds_write_b64 v228, v[100:101] offset:8192
    ds_write_b64 v228, v[102:103] offset:8704
    ds_write_b64 v228, v[104:105] offset:9216
    ds_write_b64 v228, v[106:107] offset:9728
    s_mov_b64 exec, -1
    s_cmp_eq_u32 s14, 0
    s_cbranch_scc1 nodl_32
    buffer_load_dwordx2 v[180:181], v253, s[56:59], s78 offen offset:0 nt
    buffer_load_dwordx2 v[182:183], v253, s[56:59], s78 offen offset:2048 nt
    s_add_u32 s78, s78, 4096
    buffer_load_dwordx2 v[184:185], v253, s[56:59], s78 offen offset:0 nt
    buffer_load_dwordx2 v[186:187], v253, s[56:59], s78 offen offset:2048 nt
    s_add_u32 s78, s78, 249856
    buffer_load_dwordx2 v[188:189], v253, s[56:59], s78 offen offset:0 nt
    buffer_load_dwordx2 v[190:191], v253, s[56:59], s78 offen offset:2048 nt
    s_add_u32 s78, s78, 4096
    buffer_load_dwordx2 v[192:193], v253, s[56:59], s78 offen offset:0 nt
    buffer_load_dwordx2 v[194:195], v253, s[56:59], s78 offen offset:2048 nt
    s_add_u32 s78, s78, 4096
nodl_32:
    v_add_f32 v90, 1.0, v90
    v_add_f32 v91, 1.0, v91
    v_add_f32 v94, 1.0, v94
    v_add_f32 v95, 1.0, v95
    v_pk_fma_f32 v[4:5], v[4:5], v[90:91], v[88:89]
    v_pk_fma_f32 v[6:7], v[6:7], v[90:91], v[88:89]
    v_pk_fma_f32 v[8:9], v[8:9], v[90:91], v[88:89]
    v_pk_fma_f32 v[10:11], v[10:11], v[90:91], v[88:89]
    v_pk_fma_f32 v[12:13], v[12:13], v[90:91], v[88:89]
    v_pk_fma_f32 v[14:15], v[14:15], v[90:91], v[88:89]
    v_pk_fma_f32 v[16:17], v[16:17], v[90:91], v[88:89]
    v_pk_fma_f32 v[18:19], v[18:19], v[90:91], v[88:89]
    v_cvt_pk_bf16_f32 v52, v4, v5
    v_cvt_pk_bf16_f32 v53, v6, v7
    v_cvt_pk_bf16_f32 v54, v8, v9
    v_cvt_pk_bf16_f32 v55, v10, v11
    v_cvt_pk_bf16_f32 v56, v12, v13
    v_cvt_pk_bf16_f32 v57, v14, v15
    v_cvt_pk_bf16_f32 v58, v16, v17
    v_cvt_pk_bf16_f32 v59, v18, v19
    ds_write_b64 v229, v[52:53] offset:0
    ds_write_b64 v229, v[54:55] offset:512
    ds_write_b64 v229, v[56:57] offset:1024
    ds_write_b64 v229, v[58:59] offset:1536
    v_pk_fma_f32 v[20:21], v[20:21], v[94:95], v[92:93]
    v_pk_fma_f32 v[22:23], v[22:23], v[94:95], v[92:93]
    v_pk_fma_f32 v[24:25], v[24:25], v[94:95], v[92:93]
    v_pk_fma_f32 v[26:27], v[26:27], v[94:95], v[92:93]
    v_pk_fma_f32 v[28:29], v[28:29], v[94:95], v[92:93]
    v_pk_fma_f32 v[30:31], v[30:31], v[94:95], v[92:93]
    v_pk_fma_f32 v[32:33], v[32:33], v[94:95], v[92:93]
    v_pk_fma_f32 v[34:35], v[34:35], v[94:95], v[92:93]
    v_cvt_pk_bf16_f32 v60, v20, v21
    v_cvt_pk_bf16_f32 v61, v22, v23
    v_cvt_pk_bf16_f32 v62, v24, v25
    v_cvt_pk_bf16_f32 v63, v26, v27
    v_cvt_pk_bf16_f32 v64, v28, v29
    v_cvt_pk_bf16_f32 v65, v30, v31
    v_cvt_pk_bf16_f32 v66, v32, v33
    v_cvt_pk_bf16_f32 v67, v34, v35
    ds_write_b64 v229, v[60:61] offset:2064
    ds_write_b64 v229, v[62:63] offset:2576
    ds_write_b64 v229, v[64:65] offset:3088
    ds_write_b64 v229, v[66:67] offset:3600
    s_mov_b64 exec, 1
    ds_add_u32 v254, v255 offset:28
    s_mov_b64 exec, -1
    s_cmp_eq_u32 s14, 0
    s_cbranch_scc0 ffn2
    s_and_b32 s64, s64, 15
    s_mul_i32 s60, s64, 2064
    s_add_u32 s60, s60, 101632
    v_add_u32 v3, s60, v2
    s_xor_b32 s65, s3, 0
    s_lshl_b32 s65, s65, 4
    s_add_u32 s64, s64, s65
    s_lshl_b32 s65, s64, 11
    s_mov_b32 s61, 0
o8_spin:
    ds_read_b32 v68, v254 offset:28
    s_add_u32 s61, s61, 1
    s_waitcnt lgkmcnt(0)
    v_readfirstlane_b32 s60, v68
    s_nop 0
    s_cmp_ge_u32 s60, 12
    s_nop 1
    s_cbranch_scc1 o8_go
    s_cmp_ge_u32 s61, 4194304
    s_cbranch_scc1 o8_go
    s_sleep 1
    s_branch o8_spin
o8_go:
    s_cmp_eq_u32 s12, 0
    s_cbranch_scc0 no_cand_h
    ds_read_b128 v[68:71], v3 offset:0
    ds_read_b128 v[72:75], v3 offset:1024
    ds_read_b128 v[100:103], v2 offset:8192
    ds_read_b128 v[104:107], v2 offset:9216
    s_waitcnt lgkmcnt(3)
    buffer_store_dwordx4 v[68:71], v2, s[44:47], s65 offen offset:0 sc1
    s_waitcnt lgkmcnt(2)
    buffer_store_dwordx4 v[72:75], v2, s[44:47], s65 offen offset:1024 sc1
    s_waitcnt vmcnt(0) lgkmcnt(0)
    buffer_store_dwordx4 v[100:103], v2, s[32:35], s77 offen offset:2048 sc1
    buffer_store_dwordx4 v[104:107], v2, s[32:35], s77 offen offset:3072 sc1
    s_nop 1
no_cand_h:
    ds_read_b128 v[4:7], v235 offset:0
    ds_read_b128 v[8:11], v235 offset:1024
    ds_read_b128 v[12:15], v235 offset:2064
    ds_read_b128 v[16:19], v235 offset:3088
    ds_read_b128 v[20:23], v235 offset:4128
    ds_read_b128 v[24:27], v235 offset:5152
    ds_read_b128 v[28:31], v235 offset:6192
    ds_read_b128 v[32:35], v235 offset:7216
    s_waitcnt lgkmcnt(0)
    s_cmp_lt_u32 s3, 112
    s_cbranch_scc0 dp_go
    s_mov_b32 s61, 0
dp_spin:
    ds_read_b32 v68, v254 offset:16
    s_add_u32 s61, s61, 1
    s_waitcnt lgkmcnt(0)
    v_readfirstlane_b32 s60, v68
    s_nop 0
    s_cmp_ge_u32 s60, 8
    s_nop 1
    s_cbranch_scc1 dp_go
    s_cmp_ge_u32 s61, 4194304
    s_cbranch_scc1 dp_go
    s_sleep 2
    s_branch dp_spin
dp_go:
    s_cmp_eq_u32 s68, s64
    s_cselect_b32 s60, 0x40000000, s69
    buffer_store_dwordx4 v[4:7], v2, s[44:47], s60 offen offset:0 sc1
    buffer_store_dwordx4 v[8:11], v2, s[44:47], s60 offen offset:1024 sc1
    s_add_u32 s68, s68, 1
    s_add_u32 s69, s69, 2048
    s_cmp_eq_u32 s68, s64
    s_cselect_b32 s60, 0x40000000, s69
    buffer_store_dwordx4 v[12:15], v2, s[44:47], s60 offen offset:0 sc1
    buffer_store_dwordx4 v[16:19], v2, s[44:47], s60 offen offset:1024 sc1
    s_add_u32 s68, s68, 1
    s_add_u32 s69, s69, 2048
    s_cmp_eq_u32 s68, s64
    s_cselect_b32 s60, 0x40000000, s69
    buffer_store_dwordx4 v[20:23], v2, s[44:47], s60 offen offset:0 sc1
    buffer_store_dwordx4 v[24:27], v2, s[44:47], s60 offen offset:1024 sc1
    s_add_u32 s68, s68, 1
    s_add_u32 s69, s69, 2048
    s_cmp_eq_u32 s68, s64
    s_cselect_b32 s60, 0x40000000, s69
    buffer_store_dwordx4 v[28:31], v2, s[44:47], s60 offen offset:0 sc1
    buffer_store_dwordx4 v[32:35], v2, s[44:47], s60 offen offset:1024 sc1
    s_nop 0
    s_branch main_fl
ffn2:
    s_cmp_lt_u32 s3, 112
    s_cbranch_scc0 main_fl
    buffer_load_dwordx2 v[196:197], v253, s[56:59], s78 offen offset:0 nt
    buffer_load_dwordx2 v[198:199], v253, s[56:59], s78 offen offset:2048 nt
    s_add_u32 s78, s78, 4096
    buffer_load_dwordx2 v[200:201], v253, s[56:59], s78 offen offset:0 nt
    buffer_load_dwordx2 v[202:203], v253, s[56:59], s78 offen offset:2048 nt
    s_add_u32 s78, s78, 249856
    buffer_load_dwordx2 v[204:205], v253, s[56:59], s78 offen offset:0 nt
    buffer_load_dwordx2 v[206:207], v253, s[56:59], s78 offen offset:2048 nt
    s_add_u32 s78, s78, 4096
    buffer_load_dwordx2 v[208:209], v253, s[56:59], s78 offen offset:0 nt
    buffer_load_dwordx2 v[210:211], v253, s[56:59], s78 offen offset:2048 nt
    s_add_u32 s78, s78, 4096
    buffer_load_dwordx2 v[212:213], v253, s[56:59], s78 offen offset:0 nt
    buffer_load_dwordx2 v[214:215], v253, s[56:59], s78 offen offset:2048 nt
    s_add_u32 s78, s78, 4096
    buffer_load_dwordx2 v[216:217], v253, s[56:59], s78 offen offset:0 nt
    buffer_load_dwordx2 v[218:219], v253, s[56:59], s78 offen offset:2048 nt
    s_add_u32 s78, s78, 249856
    s_lshl_b32 s77, s3, 14
    s_add_u32 s77, s77, 2101248
    s_add_u32 s63, s79, 4096
    s_mov_b32 s62, s63
    s_waitcnt vmcnt(24)
    v_perm_b32 v48, v164, v156, s74
    v_perm_b32 v164, v164, v156, s75
    v_mov_b32 v156, v48
    v_perm_b32 v49, v165, v157, s74
    v_perm_b32 v165, v165, v157, s75
    v_mov_b32 v157, v49
    v_perm_b32 v48, v166, v158, s74
    v_perm_b32 v166, v166, v158, s75
    v_mov_b32 v158, v48
    v_perm_b32 v49, v167, v159, s74
    v_perm_b32 v167, v167, v159, s75
    v_mov_b32 v159, v49
    v_perm_b32 v48, v168, v160, s74
    v_perm_b32 v168, v168, v160, s75
    v_mov_b32 v160, v48
    v_perm_b32 v49, v169, v161, s74
    v_perm_b32 v169, v169, v161, s75
    v_mov_b32 v161, v49
    v_perm_b32 v48, v170, v162, s74
    v_perm_b32 v170, v170, v162, s75
    v_mov_b32 v162, v48
    v_perm_b32 v49, v171, v163, s74
    v_perm_b32 v171, v171, v163, s75
    v_mov_b32 v163, v49
    s_waitcnt vmcnt(16)
    v_perm_b32 v48, v180, v172, s74
    v_perm_b32 v180, v180, v172, s75
    v_mov_b32 v172, v48
    v_perm_b32 v49, v181, v173, s74
    v_perm_b32 v181, v181, v173, s75
    v_mov_b32 v173, v49
    v_perm_b32 v48, v182, v174, s74
    v_perm_b32 v182, v182, v174, s75
    v_mov_b32 v174, v48
    v_perm_b32 v49, v183, v175, s74
    v_perm_b32 v183, v183, v175, s75
    v_mov_b32 v175, v49
    v_perm_b32 v48, v184, v176, s74
    v_perm_b32 v184, v184, v176, s75
    v_mov_b32 v176, v48
    v_perm_b32 v49, v185, v177, s74
    v_perm_b32 v185, v185, v177, s75
    v_mov_b32 v177, v49
    v_perm_b32 v48, v186, v178, s74
    v_perm_b32 v186, v186, v178, s75
    v_mov_b32 v178, v48
    v_perm_b32 v49, v187, v179, s74
    v_perm_b32 v187, v187, v179, s75
    v_mov_b32 v179, v49
    s_waitcnt vmcnt(8)
    v_perm_b32 v48, v196, v188, s74
    v_perm_b32 v196, v196, v188, s75
    v_mov_b32 v188, v48
    v_perm_b32 v49, v197, v189, s74
    v_perm_b32 v197, v197, v189, s75
    v_mov_b32 v189, v49
    v_perm_b32 v48, v198, v190, s74
    v_perm_b32 v198, v198, v190, s75
    v_mov_b32 v190, v48
    v_perm_b32 v49, v199, v191, s74
    v_perm_b32 v199, v199, v191, s75
    v_mov_b32 v191, v49
    v_perm_b32 v48, v200, v192, s74
    v_perm_b32 v200, v200, v192, s75
    v_mov_b32 v192, v48
    v_perm_b32 v49, v201, v193, s74
    v_perm_b32 v201, v201, v193, s75
    v_mov_b32 v193, v49
    v_perm_b32 v48, v202, v194, s74
    v_perm_b32 v202, v202, v194, s75
    v_mov_b32 v194, v48
    v_perm_b32 v49, v203, v195, s74
    v_perm_b32 v203, v203, v195, s75
    v_mov_b32 v195, v49
    s_waitcnt vmcnt(0)
    s_mov_b64 exec, 1
    ds_add_u32 v254, v255 offset:16
    s_mov_b64 exec, -1
    buffer_load_dwordx4 v[52:55], v2, s[32:35], s62 offen offset:0 sc1
    buffer_load_dwordx4 v[56:59], v2, s[32:35], s62 offen offset:1024 sc1
    buffer_load_dwordx4 v[60:63], v2, s[32:35], s62 offen offset:2048 sc1
    buffer_load_dwordx4 v[64:67], v2, s[32:35], s62 offen offset:3072 sc1
    v_perm_b32 v48, v212, v204, s74
    v_perm_b32 v212, v212, v204, s75
    v_mov_b32 v204, v48
    v_perm_b32 v49, v213, v205, s74
    v_perm_b32 v213, v213, v205, s75
    v_mov_b32 v205, v49
    v_perm_b32 v48, v214, v206, s74
    v_perm_b32 v214, v214, v206, s75
    v_mov_b32 v206, v48
    v_perm_b32 v49, v215, v207, s74
    v_perm_b32 v215, v215, v207, s75
    v_mov_b32 v207, v49
    v_perm_b32 v48, v216, v208, s74
    v_perm_b32 v216, v216, v208, s75
    v_mov_b32 v208, v48
    v_perm_b32 v49, v217, v209, s74
    v_perm_b32 v217, v217, v209, s75
    v_mov_b32 v209, v49
    v_perm_b32 v48, v218, v210, s74
    v_perm_b32 v218, v218, v210, s75
    v_mov_b32 v210, v48
    v_perm_b32 v49, v219, v211, s74
    v_perm_b32 v219, v219, v211, s75
    v_mov_b32 v211, v49
    s_mov_b32 s61, 0
    s_branch pg_chk
pg_again:
    buffer_load_dwordx4 v[52:55], v2, s[32:35], s62 offen offset:0 sc1
    buffer_load_dwordx4 v[56:59], v2, s[32:35], s62 offen offset:1024 sc1
    buffer_load_dwordx4 v[60:63], v2, s[32:35], s62 offen offset:2048 sc1
    buffer_load_dwordx4 v[64:67], v2, s[32:35], s62 offen offset:3072 sc1
pg_chk:
    s_waitcnt vmcnt(0)
    v_max3_u32 v68, v52, v53, v54
    v_max3_u32 v68, v68, v55, v56
    v_max3_u32 v68, v68, v57, v58
    v_max3_u32 v68, v68, v59, v60
    v_max3_u32 v68, v68, v61, v62
    v_max3_u32 v68, v68, v63, v64
    v_max3_u32 v68, v68, v65, v66
    v_max_u32 v68, v68, v67
    v_cmp_eq_u32 vcc, -1, v68
    s_nop 3
    s_cbranch_vccz pg_ok
    s_add_u32 s61, s61, 1
    s_cmp_ge_u32 s61, 65536
    s_cbranch_scc1 pg_ok
    s_mov_b64 exec, vcc
    s_cmp_lt_u32 s61, 16
    s_cselect_b32 s62, s63, s79
    s_sleep 2
    s_branch pg_again
pg_ok:
    s_mov_b64 exec, -1
    v_pk_add_f32 v[52:53], v[52:53], v[56:57]
    v_pk_add_f32 v[54:55], v[54:55], v[58:59]
    v_pk_add_f32 v[60:61], v[60:61], v[64:65]
    v_pk_add_f32 v[62:63], v[62:63], v[66:67]
    v_pk_add_f32 v[52:53], v[52:53], v[60:61]
    v_pk_add_f32 v[54:55], v[54:55], v[62:63]
    s_nop 1
    v_permlane32_swap_b32 v52, v54
    v_permlane32_swap_b32 v53, v55
    v_pk_add_f32 v[52:53], v[52:53], v[54:55]
    s_nop 1
    v_permlane16_swap_b32 v52, v53
    v_add_f32 v8, v52, v53
    v_cvt_pk_bf16_f32 v8, 0, v8
    v_mul_f32 v10, 0xbfb8aa3b, v8
    s_nop 0
    v_mov_b32_dpp v11, v8 row_ror:8 row_mask:0xf bank_mask:0xf
    v_exp_f32 v10, v10
    s_nop 0
    v_add_f32 v10, 1.0, v10
    v_rcp_f32 v10, v10
    s_nop 0
    v_mul_f32 v8, v8, v10
    v_cvt_pk_bf16_f32 v8, 0, v8
    v_mul_f32 v8, v8, v11
    s_nop 1
    v_mov_b32_dpp v9, v8 row_shr:1 row_mask:0xf bank_mask:0xf bound_ctrl:0
    v_cvt_pk_bf16_f32 v8, v9, v8
    s_nop 0
    v_readlane_b32 s16, v8, 1
    v_readlane_b32 s17, v8, 17
    v_readlane_b32 s18, v8, 33
    v_readlane_b32 s19, v8, 49
    v_readlane_b32 s20, v8, 3
    v_readlane_b32 s21, v8, 19
    v_readlane_b32 s22, v8, 35
    v_readlane_b32 s23, v8, 51
    v_readlane_b32 s24, v8, 5
    v_readlane_b32 s25, v8, 21
    v_readlane_b32 s26, v8, 37
    v_readlane_b32 s27, v8, 53
    v_readlane_b32 s28, v8, 7
    v_readlane_b32 s29, v8, 23
    v_readlane_b32 s30, v8, 39
    v_readlane_b32 s31, v8, 55
    v_dot2_f32_bf16 v24, v156, s16, 0
    v_dot2_f32_bf16 v25, v164, s16, 0
    v_dot2_f32_bf16 v26, v157, s16, 0
    v_dot2_f32_bf16 v27, v165, s16, 0
    v_dot2_f32_bf16 v28, v158, s17, 0
    v_dot2_f32_bf16 v29, v166, s17, 0
    v_dot2_f32_bf16 v30, v159, s17, 0
    v_dot2_f32_bf16 v31, v167, s17, 0
    v_dot2_f32_bf16 v24, v160, s18, v24
    v_dot2_f32_bf16 v25, v168, s18, v25
    v_dot2_f32_bf16 v26, v161, s18, v26
    v_dot2_f32_bf16 v27, v169, s18, v27
    v_dot2_f32_bf16 v28, v162, s19, v28
    v_dot2_f32_bf16 v29, v170, s19, v29
    v_dot2_f32_bf16 v30, v163, s19, v30
    v_dot2_f32_bf16 v31, v171, s19, v31
    v_dot2_f32_bf16 v24, v172, s20, v24
    v_dot2_f32_bf16 v25, v180, s20, v25
    v_dot2_f32_bf16 v26, v173, s20, v26
    v_dot2_f32_bf16 v27, v181, s20, v27
    v_dot2_f32_bf16 v28, v174, s21, v28
    v_dot2_f32_bf16 v29, v182, s21, v29
    v_dot2_f32_bf16 v30, v175, s21, v30
    v_dot2_f32_bf16 v31, v183, s21, v31
    v_dot2_f32_bf16 v24, v176, s22, v24
    v_dot2_f32_bf16 v25, v184, s22, v25
    v_dot2_f32_bf16 v26, v177, s22, v26
    v_dot2_f32_bf16 v27, v185, s22, v27
    v_dot2_f32_bf16 v28, v178, s23, v28
    v_dot2_f32_bf16 v29, v186, s23, v29
    v_dot2_f32_bf16 v30, v179, s23, v30
    v_dot2_f32_bf16 v31, v187, s23, v31
    v_dot2_f32_bf16 v24, v188, s24, v24
    v_dot2_f32_bf16 v25, v196, s24, v25
    v_dot2_f32_bf16 v26, v189, s24, v26
    v_dot2_f32_bf16 v27, v197, s24, v27
    v_dot2_f32_bf16 v28, v190, s25, v28
    v_dot2_f32_bf16 v29, v198, s25, v29
    v_dot2_f32_bf16 v30, v191, s25, v30
    v_dot2_f32_bf16 v31, v199, s25, v31
    v_dot2_f32_bf16 v24, v192, s26, v24
    v_dot2_f32_bf16 v25, v200, s26, v25
    v_dot2_f32_bf16 v26, v193, s26, v26
    v_dot2_f32_bf16 v27, v201, s26, v27
    v_dot2_f32_bf16 v28, v194, s27, v28
    v_dot2_f32_bf16 v29, v202, s27, v29
    v_dot2_f32_bf16 v30, v195, s27, v30
    v_dot2_f32_bf16 v31, v203, s27, v31
    v_dot2_f32_bf16 v24, v204, s28, v24
    v_dot2_f32_bf16 v25, v212, s28, v25
    v_dot2_f32_bf16 v26, v205, s28, v26
    v_dot2_f32_bf16 v27, v213, s28, v27
    v_dot2_f32_bf16 v28, v206, s29, v28
    v_dot2_f32_bf16 v29, v214, s29, v29
    v_dot2_f32_bf16 v30, v207, s29, v30
    v_dot2_f32_bf16 v31, v215, s29, v31
    v_dot2_f32_bf16 v24, v208, s30, v24
    v_dot2_f32_bf16 v25, v216, s30, v25
    v_dot2_f32_bf16 v26, v209, s30, v26
    v_dot2_f32_bf16 v27, v217, s30, v27
    v_dot2_f32_bf16 v28, v210, s31, v28
    v_dot2_f32_bf16 v29, v218, s31, v29
    v_dot2_f32_bf16 v30, v211, s31, v30
    v_dot2_f32_bf16 v31, v219, s31, v31
    s_nop 0
    v_pk_add_f32 v[24:25], v[24:25], v[28:29]
    s_nop 0
    v_pk_add_f32 v[26:27], v[26:27], v[30:31]
    buffer_store_dwordx4 v[24:27], v237, s[32:35], s77 offen sc1
    s_mov_b64 exec, 1
    ds_add_u32 v254, v255 offset:16
    s_mov_b64 exec, -1
    s_branch main_fl
helper_ffn:
    s_cmp_lt_u32 s3, 112
    s_cbranch_scc1 ffn_go
    s_waitcnt vmcnt(0)
    s_and_b32 s60, s3, 3
    s_cbranch_scc1 main_fl
    s_barrier
    s_sleep 14
    s_branch red_entry
ffn_go:
    s_and_b32 s76, s3, 15
    s_mul_i32 s77, s76, 458752
    s_lshr_b32 s60, s3, 4
    s_lshl_b32 s60, s60, 10
    s_add_u32 s77, s77, s60
    s_lshl_b32 s60, s13, 8
    s_add_u32 s77, s77, s60
    s_lshr_b32 s78, s3, 4
    s_lshl_b32 s78, s78, 18
    s_lshl_b32 s60, s13, 5
    s_add_u32 s78, s78, s60
    s_lshl_b32 s60, s76, 8
    s_add_u32 s78, s78, s60
    s_add_u32 s78, s78, 4194304
    s_add_u32 s79, s78, 4096
    buffer_load_dwordx4 v[64:67], v252, s[48:51], s77 offen nt
    buffer_load_dwordx4 v[128:131], v252, s[52:55], s77 offen nt
    s_add_u32 s77, s77, 7168
    buffer_load_dwordx4 v[68:71], v252, s[48:51], s77 offen nt
    buffer_load_dwordx4 v[132:135], v252, s[52:55], s77 offen nt
    s_add_u32 s77, s77, 7168
    s_waitcnt vmcnt(3)
    buffer_load_dwordx4 v[72:75], v252, s[48:51], s77 offen nt
    s_waitcnt vmcnt(3)
    buffer_load_dwordx4 v[136:139], v252, s[52:55], s77 offen nt
    s_add_u32 s77, s77, 7168
    s_waitcnt vmcnt(3)
    buffer_load_dwordx4 v[76:79], v252, s[48:51], s77 offen nt
    s_waitcnt vmcnt(3)
    buffer_load_dwordx4 v[140:143], v252, s[52:55], s77 offen nt
    s_add_u32 s77, s77, 7168
    s_waitcnt vmcnt(3)
    buffer_load_dwordx4 v[80:83], v252, s[48:51], s77 offen nt
    s_waitcnt vmcnt(3)
    buffer_load_dwordx4 v[144:147], v252, s[52:55], s77 offen nt
    s_add_u32 s77, s77, 7168
    s_waitcnt vmcnt(3)
    buffer_load_dwordx4 v[84:87], v252, s[48:51], s77 offen nt
    s_waitcnt vmcnt(3)
    buffer_load_dwordx4 v[148:151], v252, s[52:55], s77 offen nt
    s_add_u32 s77, s77, 7168
    s_waitcnt vmcnt(3)
    s_mov_b32 s61, 0
late2_spin:
    ds_read_b32 v28, v254 offset:24
    s_add_u32 s61, s61, 1
    s_waitcnt lgkmcnt(0)
    v_readfirstlane_b32 s60, v28
    s_nop 0
    s_cmp_ge_u32 s60, 1
    s_nop 1
    s_cbranch_scc1 late2_go
    s_cmp_ge_u32 s61, 4194304
    s_cbranch_scc1 late2_go
    s_sleep 6
    s_branch late2_spin
late2_go:
    s_mov_b32 s61, 0
yw_spin:
    ds_read_b32 v28, v254 offset:8
    s_add_u32 s61, s61, 1
    s_waitcnt lgkmcnt(0)
    v_readfirstlane_b32 s60, v28
    s_nop 0
    s_cmp_ge_u32 s60, 8
    s_nop 1
    s_cbranch_scc1 yw_go
    s_cmp_ge_u32 s61, 4194304
    s_cbranch_scc1 yw_go
    s_sleep 1
    s_branch yw_spin
yw_go:
    buffer_load_dwordx4 v[88:91], v252, s[48:51], s77 offen nt
    s_waitcnt vmcnt(3)
    buffer_load_dwordx4 v[152:155], v252, s[52:55], s77 offen nt
    s_add_u32 s77, s77, 7168
    s_waitcnt vmcnt(3)
    buffer_load_dwordx4 v[92:95], v252, s[48:51], s77 offen nt
    s_waitcnt vmcnt(3)
    buffer_load_dwordx4 v[156:159], v252, s[52:55], s77 offen nt
    s_add_u32 s77, s77, 7168
    s_waitcnt vmcnt(3)
    buffer_load_dwordx4 v[96:99], v252, s[48:51], s77 offen nt
    s_waitcnt vmcnt(3)
    buffer_load_dwordx4 v[160:163], v252, s[52:55], s77 offen nt
    s_add_u32 s77, s77, 7168
    s_waitcnt vmcnt(3)
    buffer_load_dwordx4 v[100:103], v252, s[48:51], s77 offen nt
    buffer_load_dwordx4 v[164:167], v252, s[52:55], s77 offen nt
    s_add_u32 s77, s77, 7168
    buffer_load_dwordx4 v[104:107], v252, s[48:51], s77 offen nt
    buffer_load_dwordx4 v[168:171], v252, s[52:55], s77 offen nt
    s_add_u32 s77, s77, 7168
    buffer_load_dwordx4 v[108:111], v252, s[48:51], s77 offen nt
    buffer_load_dwordx4 v[172:175], v252, s[52:55], s77 offen nt
    s_add_u32 s77, s77, 7168
    buffer_load_dwordx4 v[112:115], v252, s[48:51], s77 offen nt
    buffer_load_dwordx4 v[176:179], v252, s[52:55], s77 offen nt
    s_add_u32 s77, s77, 7168
    buffer_load_dwordx4 v[116:119], v252, s[48:51], s77 offen nt
    buffer_load_dwordx4 v[180:183], v252, s[52:55], s77 offen nt
    s_add_u32 s77, s77, 7168
    buffer_load_dwordx4 v[120:123], v252, s[48:51], s77 offen nt
    buffer_load_dwordx4 v[184:187], v252, s[52:55], s77 offen nt
    s_add_u32 s77, s77, 7168
    buffer_load_dwordx4 v[124:127], v252, s[48:51], s77 offen nt
    buffer_load_dwordx4 v[188:191], v252, s[52:55], s77 offen nt
    s_add_u32 s77, s77, 7168
    s_waitcnt vmcnt(28)
    v_perm_b32 v32, v68, v64, s74
    v_perm_b32 v68, v68, v64, s75
    v_mov_b32 v64, v32
    v_perm_b32 v33, v69, v65, s74
    v_perm_b32 v69, v69, v65, s75
    v_mov_b32 v65, v33
    v_perm_b32 v34, v70, v66, s74
    v_perm_b32 v70, v70, v66, s75
    v_mov_b32 v66, v34
    v_perm_b32 v35, v71, v67, s74
    v_perm_b32 v71, v71, v67, s75
    v_mov_b32 v67, v35
    v_perm_b32 v32, v132, v128, s74
    v_perm_b32 v132, v132, v128, s75
    v_mov_b32 v128, v32
    v_perm_b32 v33, v133, v129, s74
    v_perm_b32 v133, v133, v129, s75
    v_mov_b32 v129, v33
    v_perm_b32 v34, v134, v130, s74
    v_perm_b32 v134, v134, v130, s75
    v_mov_b32 v130, v34
    v_perm_b32 v35, v135, v131, s74
    v_perm_b32 v135, v135, v131, s75
    v_mov_b32 v131, v35
    s_waitcnt vmcnt(24)
    v_perm_b32 v32, v76, v72, s74
    v_perm_b32 v76, v76, v72, s75
    v_mov_b32 v72, v32
    v_perm_b32 v33, v77, v73, s74
    v_perm_b32 v77, v77, v73, s75
    v_mov_b32 v73, v33
    v_perm_b32 v34, v78, v74, s74
    v_perm_b32 v78, v78, v74, s75
    v_mov_b32 v74, v34
    v_perm_b32 v35, v79, v75, s74
    v_perm_b32 v79, v79, v75, s75
    v_mov_b32 v75, v35
    v_perm_b32 v32, v140, v136, s74
    v_perm_b32 v140, v140, v136, s75
    v_mov_b32 v136, v32
    v_perm_b32 v33, v141, v137, s74
    v_perm_b32 v141, v141, v137, s75
    v_mov_b32 v137, v33
    v_perm_b32 v34, v142, v138, s74
    v_perm_b32 v142, v142, v138, s75
    v_mov_b32 v138, v34
    v_perm_b32 v35, v143, v139, s74
    v_perm_b32 v143, v143, v139, s75
    v_mov_b32 v139, v35
    s_waitcnt vmcnt(20)
    v_perm_b32 v32, v84, v80, s74
    v_perm_b32 v84, v84, v80, s75
    v_mov_b32 v80, v32
    v_perm_b32 v33, v85, v81, s74
    v_perm_b32 v85, v85, v81, s75
    v_mov_b32 v81, v33
    v_perm_b32 v34, v86, v82, s74
    v_perm_b32 v86, v86, v82, s75
    v_mov_b32 v82, v34
    v_perm_b32 v35, v87, v83, s74
    v_perm_b32 v87, v87, v83, s75
    v_mov_b32 v83, v35
    v_perm_b32 v32, v148, v144, s74
    v_perm_b32 v148, v148, v144, s75
    v_mov_b32 v144, v32
    v_perm_b32 v33, v149, v145, s74
    v_perm_b32 v149, v149, v145, s75
    v_mov_b32 v145, v33
    v_perm_b32 v34, v150, v146, s74
    v_perm_b32 v150, v150, v146, s75
    v_mov_b32 v146, v34
    v_perm_b32 v35, v151, v147, s74
    v_perm_b32 v151, v151, v147, s75
    v_mov_b32 v147, v35
    s_waitcnt vmcnt(16)
    v_perm_b32 v32, v92, v88, s74
    v_perm_b32 v92, v92, v88, s75
    v_mov_b32 v88, v32
    v_perm_b32 v33, v93, v89, s74
    v_perm_b32 v93, v93, v89, s75
    v_mov_b32 v89, v33
    v_perm_b32 v34, v94, v90, s74
    v_perm_b32 v94, v94, v90, s75
    v_mov_b32 v90, v34
    v_perm_b32 v35, v95, v91, s74
    v_perm_b32 v95, v95, v91, s75
    v_mov_b32 v91, v35
    v_perm_b32 v32, v156, v152, s74
    v_perm_b32 v156, v156, v152, s75
    v_mov_b32 v152, v32
    v_perm_b32 v33, v157, v153, s74
    v_perm_b32 v157, v157, v153, s75
    v_mov_b32 v153, v33
    v_perm_b32 v34, v158, v154, s74
    v_perm_b32 v158, v158, v154, s75
    v_mov_b32 v154, v34
    v_perm_b32 v35, v159, v155, s74
    v_perm_b32 v159, v159, v155, s75
    v_mov_b32 v155, v35
    s_waitcnt vmcnt(12)
    v_perm_b32 v32, v100, v96, s74
    v_perm_b32 v100, v100, v96, s75
    v_mov_b32 v96, v32
    v_perm_b32 v33, v101, v97, s74
    v_perm_b32 v101, v101, v97, s75
    v_mov_b32 v97, v33
    v_perm_b32 v34, v102, v98, s74
    v_perm_b32 v102, v102, v98, s75
    v_mov_b32 v98, v34
    v_perm_b32 v35, v103, v99, s74
    v_perm_b32 v103, v103, v99, s75
    v_mov_b32 v99, v35
    v_perm_b32 v32, v164, v160, s74
    v_perm_b32 v164, v164, v160, s75
    v_mov_b32 v160, v32
    v_perm_b32 v33, v165, v161, s74
    v_perm_b32 v165, v165, v161, s75
    v_mov_b32 v161, v33
    v_perm_b32 v34, v166, v162, s74
    v_perm_b32 v166, v166, v162, s75
    v_mov_b32 v162, v34
    v_perm_b32 v35, v167, v163, s74
    v_perm_b32 v167, v167, v163, s75
    v_mov_b32 v163, v35
    s_waitcnt vmcnt(8)
    v_perm_b32 v32, v108, v104, s74
    v_perm_b32 v108, v108, v104, s75
    v_mov_b32 v104, v32
    v_perm_b32 v33, v109, v105, s74
    v_perm_b32 v109, v109, v105, s75
    v_mov_b32 v105, v33
    v_perm_b32 v34, v110, v106, s74
    v_perm_b32 v110, v110, v106, s75
    v_mov_b32 v106, v34
    v_perm_b32 v35, v111, v107, s74
    v_perm_b32 v111, v111, v107, s75
    v_mov_b32 v107, v35
    v_perm_b32 v32, v172, v168, s74
    v_perm_b32 v172, v172, v168, s75
    v_mov_b32 v168, v32
    v_perm_b32 v33, v173, v169, s74
    v_perm_b32 v173, v173, v169, s75
    v_mov_b32 v169, v33
    v_perm_b32 v34, v174, v170, s74
    v_perm_b32 v174, v174, v170, s75
    v_mov_b32 v170, v34
    v_perm_b32 v35, v175, v171, s74
    v_perm_b32 v175, v175, v171, s75
    v_mov_b32 v171, v35
    s_waitcnt vmcnt(4)
    v_perm_b32 v32, v116, v112, s74
    v_perm_b32 v116, v116, v112, s75
    v_mov_b32 v112, v32
    v_perm_b32 v33, v117, v113, s74
    v_perm_b32 v117, v117, v113, s75
    v_mov_b32 v113, v33
    v_perm_b32 v34, v118, v114, s74
    v_perm_b32 v118, v118, v114, s75
    v_mov_b32 v114, v34
    v_perm_b32 v35, v119, v115, s74
    v_perm_b32 v119, v119, v115, s75
    v_mov_b32 v115, v35
    v_perm_b32 v32, v180, v176, s74
    v_perm_b32 v180, v180, v176, s75
    v_mov_b32 v176, v32
    v_perm_b32 v33, v181, v177, s74
    v_perm_b32 v181, v181, v177, s75
    v_mov_b32 v177, v33
    v_perm_b32 v34, v182, v178, s74
    v_perm_b32 v182, v182, v178, s75
    v_mov_b32 v178, v34
    v_perm_b32 v35, v183, v179, s74
    v_perm_b32 v183, v183, v179, s75
    v_mov_b32 v179, v35
    s_waitcnt vmcnt(0)
    v_perm_b32 v32, v124, v120, s74
    v_perm_b32 v124, v124, v120, s75
    v_mov_b32 v120, v32
    v_perm_b32 v33, v125, v121, s74
    v_perm_b32 v125, v125, v121, s75
    v_mov_b32 v121, v33
    v_perm_b32 v34, v126, v122, s74
    v_perm_b32 v126, v126, v122, s75
    v_mov_b32 v122, v34
    v_perm_b32 v35, v127, v123, s74
    v_perm_b32 v127, v127, v123, s75
    v_mov_b32 v123, v35
    v_perm_b32 v32, v188, v184, s74
    v_perm_b32 v188, v188, v184, s75
    v_mov_b32 v184, v32
    v_perm_b32 v33, v189, v185, s74
    v_perm_b32 v189, v189, v185, s75
    v_mov_b32 v185, v33
    v_perm_b32 v34, v190, v186, s74
    v_perm_b32 v190, v190, v186, s75
    v_mov_b32 v186, v34
    v_perm_b32 v35, v191, v187, s74
    v_perm_b32 v191, v191, v187, s75
    v_mov_b32 v187, v35
    s_nop 1
f2_bar:
    s_barrier
f1_body:
    ds_read_b128 v[36:39], v201
    ds_read_b128 v[40:43], v201 offset:16
    s_waitcnt lgkmcnt(1)
    v_dot2_f32_bf16 v44, v64, v36, 0
    v_dot2_f32_bf16 v45, v68, v36, 0
    v_dot2_f32_bf16 v46, v65, v36, 0
    v_dot2_f32_bf16 v47, v69, v36, 0
    v_dot2_f32_bf16 v48, v66, v36, 0
    v_dot2_f32_bf16 v49, v70, v36, 0
    v_dot2_f32_bf16 v50, v67, v36, 0
    v_dot2_f32_bf16 v51, v71, v36, 0
    v_dot2_f32_bf16 v52, v128, v36, 0
    v_dot2_f32_bf16 v53, v132, v36, 0
    v_dot2_f32_bf16 v54, v129, v36, 0
    v_dot2_f32_bf16 v55, v133, v36, 0
    v_dot2_f32_bf16 v56, v130, v36, 0
    v_dot2_f32_bf16 v57, v134, v36, 0
    v_dot2_f32_bf16 v58, v131, v36, 0
    v_dot2_f32_bf16 v59, v135, v36, 0
    v_dot2_f32_bf16 v44, v72, v37, v44
    v_dot2_f32_bf16 v45, v76, v37, v45
    v_dot2_f32_bf16 v46, v73, v37, v46
    v_dot2_f32_bf16 v47, v77, v37, v47
    v_dot2_f32_bf16 v48, v74, v37, v48
    v_dot2_f32_bf16 v49, v78, v37, v49
    v_dot2_f32_bf16 v50, v75, v37, v50
    v_dot2_f32_bf16 v51, v79, v37, v51
    v_dot2_f32_bf16 v52, v136, v37, v52
    v_dot2_f32_bf16 v53, v140, v37, v53
    v_dot2_f32_bf16 v54, v137, v37, v54
    v_dot2_f32_bf16 v55, v141, v37, v55
    v_dot2_f32_bf16 v56, v138, v37, v56
    v_dot2_f32_bf16 v57, v142, v37, v57
    v_dot2_f32_bf16 v58, v139, v37, v58
    v_dot2_f32_bf16 v59, v143, v37, v59
    v_dot2_f32_bf16 v44, v80, v38, v44
    v_dot2_f32_bf16 v45, v84, v38, v45
    v_dot2_f32_bf16 v46, v81, v38, v46
    v_dot2_f32_bf16 v47, v85, v38, v47
    v_dot2_f32_bf16 v48, v82, v38, v48
    v_dot2_f32_bf16 v49, v86, v38, v49
    v_dot2_f32_bf16 v50, v83, v38, v50
    v_dot2_f32_bf16 v51, v87, v38, v51
    v_dot2_f32_bf16 v52, v144, v38, v52
    v_dot2_f32_bf16 v53, v148, v38, v53
    v_dot2_f32_bf16 v54, v145, v38, v54
    v_dot2_f32_bf16 v55, v149, v38, v55
    v_dot2_f32_bf16 v56, v146, v38, v56
    v_dot2_f32_bf16 v57, v150, v38, v57
    v_dot2_f32_bf16 v58, v147, v38, v58
    v_dot2_f32_bf16 v59, v151, v38, v59
    v_dot2_f32_bf16 v44, v88, v39, v44
    v_dot2_f32_bf16 v45, v92, v39, v45
    v_dot2_f32_bf16 v46, v89, v39, v46
    v_dot2_f32_bf16 v47, v93, v39, v47
    v_dot2_f32_bf16 v48, v90, v39, v48
    v_dot2_f32_bf16 v49, v94, v39, v49
    v_dot2_f32_bf16 v50, v91, v39, v50
    v_dot2_f32_bf16 v51, v95, v39, v51
    v_dot2_f32_bf16 v52, v152, v39, v52
    v_dot2_f32_bf16 v53, v156, v39, v53
    v_dot2_f32_bf16 v54, v153, v39, v54
    v_dot2_f32_bf16 v55, v157, v39, v55
    v_dot2_f32_bf16 v56, v154, v39, v56
    v_dot2_f32_bf16 v57, v158, v39, v57
    v_dot2_f32_bf16 v58, v155, v39, v58
    v_dot2_f32_bf16 v59, v159, v39, v59
    s_waitcnt lgkmcnt(0)
    v_dot2_f32_bf16 v44, v96, v40, v44
    v_dot2_f32_bf16 v45, v100, v40, v45
    v_dot2_f32_bf16 v46, v97, v40, v46
    v_dot2_f32_bf16 v47, v101, v40, v47
    v_dot2_f32_bf16 v48, v98, v40, v48
    v_dot2_f32_bf16 v49, v102, v40, v49
    v_dot2_f32_bf16 v50, v99, v40, v50
    v_dot2_f32_bf16 v51, v103, v40, v51
    v_dot2_f32_bf16 v52, v160, v40, v52
    v_dot2_f32_bf16 v53, v164, v40, v53
    v_dot2_f32_bf16 v54, v161, v40, v54
    v_dot2_f32_bf16 v55, v165, v40, v55
    v_dot2_f32_bf16 v56, v162, v40, v56
    v_dot2_f32_bf16 v57, v166, v40, v57
    v_dot2_f32_bf16 v58, v163, v40, v58
    v_dot2_f32_bf16 v59, v167, v40, v59
    v_dot2_f32_bf16 v44, v104, v41, v44
    v_dot2_f32_bf16 v45, v108, v41, v45
    v_dot2_f32_bf16 v46, v105, v41, v46
    v_dot2_f32_bf16 v47, v109, v41, v47
    v_dot2_f32_bf16 v48, v106, v41, v48
    v_dot2_f32_bf16 v49, v110, v41, v49
    v_dot2_f32_bf16 v50, v107, v41, v50
    v_dot2_f32_bf16 v51, v111, v41, v51
    v_dot2_f32_bf16 v52, v168, v41, v52
    v_dot2_f32_bf16 v53, v172, v41, v53
    v_dot2_f32_bf16 v54, v169, v41, v54
    v_dot2_f32_bf16 v55, v173, v41, v55
    v_dot2_f32_bf16 v56, v170, v41, v56
    v_dot2_f32_bf16 v57, v174, v41, v57
    v_dot2_f32_bf16 v58, v171, v41, v58
    v_dot2_f32_bf16 v59, v175, v41, v59
    v_dot2_f32_bf16 v44, v112, v42, v44
    v_dot2_f32_bf16 v45, v116, v42, v45
    v_dot2_f32_bf16 v46, v113, v42, v46
    v_dot2_f32_bf16 v47, v117, v42, v47
    v_dot2_f32_bf16 v48, v114, v42, v48
    v_dot2_f32_bf16 v49, v118, v42, v49
    v_dot2_f32_bf16 v50, v115, v42, v50
    v_dot2_f32_bf16 v51, v119, v42, v51
    v_dot2_f32_bf16 v52, v176, v42, v52
    v_dot2_f32_bf16 v53, v180, v42, v53
    v_dot2_f32_bf16 v54, v177, v42, v54
    v_dot2_f32_bf16 v55, v181, v42, v55
    v_dot2_f32_bf16 v56, v178, v42, v56
    v_dot2_f32_bf16 v57, v182, v42, v57
    v_dot2_f32_bf16 v58, v179, v42, v58
    v_dot2_f32_bf16 v59, v183, v42, v59
    v_dot2_f32_bf16 v44, v120, v43, v44
    v_dot2_f32_bf16 v45, v124, v43, v45
    v_dot2_f32_bf16 v46, v121, v43, v46
    v_dot2_f32_bf16 v47, v125, v43, v47
    v_dot2_f32_bf16 v48, v122, v43, v48
    v_dot2_f32_bf16 v49, v126, v43, v49
    v_dot2_f32_bf16 v50, v123, v43, v50
    v_dot2_f32_bf16 v51, v127, v43, v51
    v_dot2_f32_bf16 v52, v184, v43, v52
    v_dot2_f32_bf16 v53, v188, v43, v53
    v_dot2_f32_bf16 v54, v185, v43, v54
    v_dot2_f32_bf16 v55, v189, v43, v55
    v_dot2_f32_bf16 v56, v186, v43, v56
    v_dot2_f32_bf16 v57, v190, v43, v57
    v_dot2_f32_bf16 v58, v187, v43, v58
    v_dot2_f32_bf16 v59, v191, v43, v59
    v_permlane32_swap_b32 v44, v52
    v_permlane32_swap_b32 v45, v53
    v_permlane32_swap_b32 v46, v54
    v_permlane32_swap_b32 v47, v55
    v_permlane32_swap_b32 v48, v56
    v_permlane32_swap_b32 v49, v57
    v_permlane32_swap_b32 v50, v58
    v_permlane32_swap_b32 v51, v59
    v_pk_add_f32 v[44:45], v[44:45], v[52:53]
    v_pk_add_f32 v[46:47], v[46:47], v[54:55]
    v_pk_add_f32 v[48:49], v[48:49], v[56:57]
    v_pk_add_f32 v[50:51], v[50:51], v[58:59]
    s_nop 0
    v_permlane16_swap_b32 v44, v48
    v_permlane16_swap_b32 v45, v49
    v_permlane16_swap_b32 v46, v50
    v_permlane16_swap_b32 v47, v51
    v_pk_add_f32 v[44:45], v[44:45], v[48:49]
    v_pk_add_f32 v[46:47], v[46:47], v[50:51]
    buffer_store_dwordx4 v[44:47], v247, s[32:35], s79 offen
    buffer_store_dwordx4 v[44:47], v247, s[32:35], s78 offen sc1
    s_and_b32 s60, s3, 3
    s_cbranch_scc0 red_entry
    s_branch main_fl
conv_ffn:
    s_cmp_lt_u32 s3, 112
    s_cbranch_scc1 conv_tok
    s_and_b32 s60, s3, 3
    s_cbranch_scc1 main_fl
conv_tok:
    s_cmp_eq_u32 s12, 0
    s_cbranch_scc0 main_fl
    s_and_b32 s76, s3, 15
    v_lshlrev_b32 v6, 2, v1
    v_add_u32 v7, 137040, v6
    s_sleep 50
    v_lshlrev_b32 v4, 7, v1
    s_mov_b32 s64, 8192
    s_lshl_b32 s63, s76, 7
    s_add_u32 s63, s63, 2097152
    s_and_b32 s62, s3, 127
    s_lshl_b32 s62, s62, 7
    s_add_u32 s62, s62, 4
    s_mov_b64 exec, 1
    s_mov_b32 s61, 0
kc2_again:
    buffer_load_dword v8, v4, s[32:35], s62 offen sc1
kc2_chk:
    s_waitcnt vmcnt(0)
    v_cmp_ne_u32 vcc, s8, v8
    s_nop 3
    s_cbranch_vccz kc2_ok
    s_add_u32 s61, s61, 1
    s_cmp_ge_u32 s61, 65536
    s_cbranch_scc1 kc2_ok
    s_mov_b64 exec, vcc
    s_sleep 5
    s_branch kc2_again
kc2_ok:
    s_mov_b64 exec, -1
    buffer_load_dwordx2 v[16:17], v4, s[32:35], 0 offen sc1
    buffer_load_dwordx2 v[18:19], v4, s[32:35], s64 offen sc1
    s_mov_b32 s67, 0
    s_mov_b32 s61, 0
    v_mov_b32 v8, -1
    s_nop 1
ks_chk:
    s_waitcnt vmcnt(0)
    v_cmp_eq_u32 vcc, s8, v17
    v_cmp_eq_u32 s[70:71], s8, v19
    s_nop 0
    v_cndmask_b32 v12, 0, v16, vcc
    v_cndmask_b32 v9, 0, v18, s[70:71]
    s_nand_b64 s[70:71], s[70:71], vcc
    v_max_u32 v12, v12, v9
    s_nop 0
    s_cbranch_scc0 ks_all
    s_add_u32 s61, s61, 1
    s_cmp_ge_u32 s61, 65536
    s_cbranch_scc1 ks_all
    s_mov_b64 exec, s[70:71]
    s_sleep 2
    buffer_load_dwordx2 v[16:17], v4, s[32:35], 0 offen sc1
    buffer_load_dwordx2 v[18:19], v4, s[32:35], s64 offen sc1
    s_mov_b64 exec, -1
    s_nop 0
    v_max_u32_dpp v12, v12, v12 row_shr:1 row_mask:0xf bank_mask:0xf bound_ctrl:0
    s_nop 1
    v_max_u32_dpp v12, v12, v12 row_shr:2 row_mask:0xf bank_mask:0xf bound_ctrl:0
    s_nop 1
    v_max_u32_dpp v12, v12, v12 row_shr:4 row_mask:0xf bank_mask:0xf bound_ctrl:0
    s_nop 1
    v_max_u32_dpp v12, v12, v12 row_shr:8 row_mask:0xf bank_mask:0xf bound_ctrl:0
    s_nop 1
    v_max_u32_dpp v12, v12, v12 row_bcast:15 row_mask:0xa bank_mask:0xf
    s_nop 1
    v_max_u32_dpp v12, v12, v12 row_bcast:31 row_mask:0xc bank_mask:0xf
    s_nop 0
    v_readlane_b32 s65, v12, 63
    s_nop 0
    s_mov_b32 s67, s65
    s_not_b32 s66, s65
    s_bfe_u32 s66, s66, 0x70004
    s_xor_b32 s66, s66, 0
    s_lshl_b32 s66, s66, 14
    s_add_u32 s66, s66, s63
    s_mov_b32 exec_hi, 0
    buffer_load_dword v8, v6, s[32:35], s66 offen sc1
    s_mov_b64 exec, -1
    s_branch ks_chk
ks_all:
    v_max_u32_dpp v12, v12, v12 row_shr:1 row_mask:0xf bank_mask:0xf bound_ctrl:0
    s_nop 1
    v_max_u32_dpp v12, v12, v12 row_shr:2 row_mask:0xf bank_mask:0xf bound_ctrl:0
    s_nop 1
    v_max_u32_dpp v12, v12, v12 row_shr:4 row_mask:0xf bank_mask:0xf bound_ctrl:0
    s_nop 1
    v_max_u32_dpp v12, v12, v12 row_shr:8 row_mask:0xf bank_mask:0xf bound_ctrl:0
    s_nop 1
    v_max_u32_dpp v12, v12, v12 row_bcast:15 row_mask:0xa bank_mask:0xf
    s_nop 1
    v_max_u32_dpp v12, v12, v12 row_bcast:31 row_mask:0xc bank_mask:0xf
    s_nop 0
    v_readlane_b32 s65, v12, 63
    s_nop 0
    s_not_b32 s66, s65
    s_bfe_u32 s66, s66, 0x70004
    s_xor_b32 s66, s66, 0
    s_lshl_b32 s66, s66, 14
    s_add_u32 s66, s66, s63
    s_mov_b32 exec_hi, 0
    s_cmp_eq_u32 s65, s67
    s_cbranch_scc1 px_chk
    s_mov_b32 s61, 0
px_again:
    buffer_load_dword v8, v6, s[32:35], s66 offen sc1
px_chk:
    s_waitcnt vmcnt(0)
    v_cmp_eq_u32 vcc, -1, v8
    s_nop 3
    s_cbranch_vccz px_ok
    s_add_u32 s61, s61, 1
    s_cmp_ge_u32 s61, 65536
    s_cbranch_scc1 px_ok
    s_mov_b64 exec, vcc
    s_sleep 1
    s_branch px_again
px_ok:
    s_mov_b64 exec, 0xffffffff
    ds_write_b32 v7, v8
    v_mov_b32 v9, s65
    ds_write_b32 v254, v9 offset:44
    s_mov_b64 exec, -1
    s_waitcnt lgkmcnt(0)
    s_barrier
    s_branch main_fl
red_entry:
    s_lshr_b32 s76, s3, 2
    s_cmp_eq_u32 s13, 0
    s_cbranch_scc0 red_wait
    ds_read_b32 v8, v254 offset:44
    s_waitcnt lgkmcnt(0)
    v_readfirstlane_b32 s71, v8
    s_nop 0
    s_and_b32 s72, s71, 0xffff
    s_sub_u32 s72, 2047, s72
    s_lshr_b32 s73, s72, 4
    s_xor_b32 s73, s73, 0
    s_lshl_b32 s73, s73, 14
    s_lshl_b32 s60, s76, 6
    s_add_u32 s73, s73, s60
    s_add_u32 s73, s73, 2097152
    s_lshl_b32 s72, s72, 11
    s_add_u32 s72, s72, s60
    v_and_b32 v6, 15, v0
    v_lshlrev_b32 v6, 2, v6
    s_cmp_eq_u32 s76, 1
    s_cselect_b32 s60, 32768, 0x40000000
    v_mov_b32 v49, s8
    v_mov_b32 v50, 0
    s_mov_b64 exec, 1
    buffer_store_dword v49, v50, s[32:35], s60 offen
    s_mov_b64 exec, -1
    s_mov_b32 s61, 0
ph_again:
    buffer_load_dword v40, v6, s[32:35], s73 offen offset:0 sc1
    buffer_load_dword v41, v6, s[32:35], s73 offen offset:2048 sc1
ph_chk:
    s_waitcnt vmcnt(0)
    v_max_u32 v42, v40, v41
    v_cmp_eq_u32 vcc, -1, v42
    s_nop 3
    s_cbranch_vccz ph_ok
    s_add_u32 s61, s61, 1
    s_cmp_ge_u32 s61, 65536
    s_cbranch_scc1 ph_ok
    s_mov_b64 exec, vcc
    s_sleep 2
    s_branch ph_again
ph_ok:
    s_mov_b64 exec, -1
    s_and_b32 s60, s71, 0xffff0000
    s_xor_b32 s61, s60, 0x80000000
    s_xor_b32 s62, s60, 0xffff0000
    s_cmp_lt_i32 s60, 0
    s_cselect_b32 s60, s61, s62
    v_mov_b32 v42, 0xbfb8aa3b
    v_mul_f32 v42, s60, v42
    v_exp_f32 v42, v42
    s_nop 0
    v_add_f32 v42, 1.0, v42
    v_rcp_f32 v42, v42
    s_nop 0
    v_cvt_pk_bf16_f32 v42, 0, v42
    v_lshlrev_b32 v44, 16, v40
    v_and_b32 v45, 0xffff0000, v40
    v_lshlrev_b32 v46, 16, v41
    v_and_b32 v47, 0xffff0000, v41
    s_nop 1
red_wait:
    s_add_u32 s48, s32, 2101248
    s_addc_u32 s49, s33, 0
    s_mov_b32 s50, 1835008
    s_mov_b32 s51, 0x00020000
    v_and_b32 v4, 7, v0
    v_bfe_u32 v5, v0, 3, 5
    v_lshlrev_b32 v5, 14, v5
    v_lshl_add_u32 v5, v4, 4, v5
    s_lshl_b32 s64, s76, 7
    s_add_u32 s65, s64, 524288
    s_add_u32 s66, s64, 1048576
    s_add_u32 s67, s64, 1572864
    v_lshrrev_b32 v7, 4, v1
    v_lshl_add_u32 v7, v4, 2, v7
    v_lshlrev_b32 v7, 2, v7
    s_lshl_b32 s60, s13, 7
    s_add_u32 s60, s60, 138064
    v_add_u32 v7, s60, v7
    v_lshlrev_b32 v48, 3, v1
    v_add_u32 v48, 138064, v48
    s_sleep 20
    s_mov_b32 s61, 0
pp_again:
    buffer_load_dwordx4 v[8:11], v5, s[48:51], s64 offen sc1
    buffer_load_dwordx4 v[12:15], v5, s[48:51], s65 offen sc1
    buffer_load_dwordx4 v[16:19], v5, s[48:51], s66 offen sc1
    buffer_load_dwordx4 v[20:23], v5, s[48:51], s67 offen sc1
pp_chk:
    s_waitcnt vmcnt(0)
    v_max3_u32 v24, v8, v9, v10
    v_max3_u32 v24, v24, v11, v12
    v_max3_u32 v24, v24, v13, v14
    v_max3_u32 v24, v24, v15, v16
    v_max3_u32 v24, v24, v17, v18
    v_max3_u32 v24, v24, v19, v20
    v_max3_u32 v24, v24, v21, v22
    v_max_u32 v24, v24, v23
    v_cmp_eq_u32 vcc, -1, v24
    s_nop 3
    s_cbranch_vccz pp_ok
    s_add_u32 s61, s61, 1
    s_cmp_ge_u32 s61, 65536
    s_cbranch_scc1 pp_ok
    s_mov_b64 exec, vcc
    s_sleep 2
    s_branch pp_again
pp_ok:
    s_mov_b64 exec, -1
    v_pk_add_f32 v[8:9], v[8:9], v[12:13]
    v_pk_add_f32 v[10:11], v[10:11], v[14:15]
    v_pk_add_f32 v[16:17], v[16:17], v[20:21]
    v_pk_add_f32 v[18:19], v[18:19], v[22:23]
    v_pk_add_f32 v[8:9], v[8:9], v[16:17]
    v_pk_add_f32 v[10:11], v[10:11], v[18:19]
    s_nop 1
    v_permlane32_swap_b32 v8, v10
    v_permlane32_swap_b32 v9, v11
    v_pk_add_f32 v[8:9], v[8:9], v[10:11]
    s_nop 1
    v_permlane16_swap_b32 v8, v9
    v_add_f32 v8, v8, v9
    s_nop 1
    v_add_f32_dpp v8, v8, v8 row_ror:8 row_mask:0xf bank_mask:0xf
    ds_write_b32 v7, v8
    s_mov_b64 exec, 1
    ds_add_u32 v254, v255 offset:40
    s_mov_b64 exec, -1
    s_cmp_eq_u32 s13, 0
    s_cbranch_scc0 main_fl
    s_mov_b32 s61, 0
r3_spin:
    ds_read_b32 v24, v254 offset:40
    s_add_u32 s61, s61, 1
    s_waitcnt lgkmcnt(0)
    v_readfirstlane_b32 s60, v24
    s_nop 0
    s_cmp_ge_u32 s60, 4
    s_nop 1
    s_cbranch_scc1 r3_go
    s_cmp_ge_u32 s61, 4194304
    s_cbranch_scc1 r3_go
    s_sleep 0
    s_branch r3_spin
r3_go:
    s_mov_b64 exec, 0xffff
    ds_read_b64 v[8:9], v48 offset:0
    ds_read_b64 v[10:11], v48 offset:128
    ds_read_b64 v[12:13], v48 offset:256
    ds_read_b64 v[14:15], v48 offset:384
    s_waitcnt lgkmcnt(0)
    v_pk_add_f32 v[8:9], v[8:9], v[10:11]
    v_pk_add_f32 v[12:13], v[12:13], v[14:15]
    v_pk_add_f32 v[8:9], v[8:9], v[12:13]
    v_cvt_pk_bf16_f32 v8, 0, v8
    v_cvt_pk_bf16_f32 v9, 0, v9
    v_mul_f32 v8, v8, v42
    v_mul_f32 v9, v9, v42
    v_cvt_pk_bf16_f32 v8, 0, v8
    v_cvt_pk_bf16_f32 v9, 0, v9
    v_pk_add_f32 v[8:9], v[8:9], v[44:45]
    v_cvt_pk_bf16_f32 v8, 0, v8
    v_cvt_pk_bf16_f32 v9, 0, v9
    v_pk_add_f32 v[8:9], v[8:9], v[46:47]
    v_cvt_pk_bf16_f32 v8, v8, v9
    buffer_store_dword v8, v6, s[44:47], s72 offen
    s_nop 0
main_fl:
main_done:
    s_endpgm
.section .rodata,"a"
.p2align 6
.amdhsa_kernel sequential_preLN__ssm_conv_h3__moe_arch_mod__prompt_kernel
  .amdhsa_next_free_vgpr 256
  .amdhsa_next_free_sgpr 80
  .amdhsa_accum_offset 256
  .amdhsa_group_segment_fixed_size 0
  .amdhsa_kernarg_size 112
  .amdhsa_user_sgpr_count 2
  .amdhsa_user_sgpr_kernarg_segment_ptr 1
  .amdhsa_system_sgpr_workgroup_id_x 1
  .amdhsa_float_denorm_mode_32 3
.end_amdhsa_kernel
```
